```python
import torch

def _softmax(x, axis=-1):
    return torch.softmax(x, dim=axis)
def _gelu(x):
    return torch.nn.functional.gelu(x, approximate="tanh")
def _silu(x):
    return torch.nn.functional.silu(x)
def _sigmoid(x):
    return torch.sigmoid(x)
def _layernorm(x, axis=-1, eps=1e-5):
    m = x.mean(dim=axis, keepdim=True)
    v = x.var(dim=axis, keepdim=True, unbiased=False)
    return (x - m) / torch.sqrt(v + eps)
def _scatter_add(tgt, idx, src, axis=0):
    return tgt.clone().index_add_(axis, idx, src)
def _segment_sum(src, seg, n):
    out = torch.zeros((n,) + src.shape[1:], dtype=src.dtype)
    return out.index_add_(0, seg, src)
def _pad(x, pw):
    flat = tuple(v for pair in reversed(pw) for v in pair)
    return torch.nn.functional.pad(x, flat)

kernel_name = 'parallel_sum__sliding_block_cached__geglu_ffn__decode'

def setup_inputs():

    _w = (lambda a: (lambda t: t.to(torch.bfloat16) if t.is_floating_point() else t)(torch.as_tensor(a)))
    def _A_setup():
        B, Sq, D = 2, 1, 576
        Hq, Hkv, Sk, Dh = 32, 16, 4096, 128
        assert Hq % Hkv == 0, (Hq, Hkv)
        return {
            "x": _w((lambda *s: torch.randn(*s, dtype=torch.bfloat16) * 0.05)(B, Sq, D)),
            "k_cache": _w((lambda *s: torch.randn(*s, dtype=torch.bfloat16) * 3.2)(B, Hkv, Sk, Dh)),
            "v_cache": _w((lambda *s: torch.randn(*s, dtype=torch.bfloat16) * 1.6)(B, Hkv, Sk, Dh)),
            "wq": _w((lambda *s: torch.randn(*s, dtype=torch.bfloat16) * 3.2)(D, Hq * Dh) * (D ** -0.5)),
            "wo": _w((lambda *s: torch.randn(*s, dtype=torch.bfloat16) * 1.6)(Hq * Dh, D) * ((Hq * Dh) ** -0.5)),
        }
    _A_in = _A_setup()

    def _B_setup():
        B, S, D, F = 2, 1, 576, 4608
        return {
            "x": _w((lambda *s: torch.randn(*s, dtype=torch.bfloat16) * 0.05)(B, S, D)),
            "w_gate": _w((lambda *s: torch.randn(*s, dtype=torch.bfloat16) * 0.05)(D, F)),
            "w_up": _w((lambda *s: torch.randn(*s, dtype=torch.bfloat16) * 0.05)(D, F)),
            "w_down": _w((lambda *s: torch.randn(*s, dtype=torch.bfloat16) * 0.05)(F, D)),
        }
    _B_in = _B_setup()

    return {
        "A_x": _A_in["x"],
        "A_k_cache": _A_in["k_cache"],
        "A_v_cache": _A_in["v_cache"],
        "A_wq": _A_in["wq"],
        "A_wo": _A_in["wo"],
        "B_x": _B_in["x"],
        "B_w_gate": _B_in["w_gate"],
        "B_w_up": _B_in["w_up"],
        "B_w_down": _B_in["w_down"],
    }

def reference(A_x, A_k_cache, A_v_cache, A_wq, A_wo, B_x, B_w_gate, B_w_up, B_w_down):
    def _A_ref(x, k_cache, v_cache, wq, wo):
        B, Sq, D = x.shape
        Hq, Dh = 32, 128
        Hkv, Sk = k_cache.shape[1], k_cache.shape[2]
        W = min(4096, max(256, Sk // 4))
        rep = Hq // Hkv
        q = (lambda x, *d: x.permute(*d))((x @ wq).reshape(B, Sq, Hq, Dh), 0, 2, 1, 3)
        k = (lambda x, n, axis: torch.repeat_interleave(x, n, dim=axis))(k_cache[:, :, Sk - W:, :], rep, axis=1)
        v = (lambda x, n, axis: torch.repeat_interleave(x, n, dim=axis))(v_cache[:, :, Sk - W:, :], rep, axis=1)
        scores = torch.einsum("bhqd,bhkd->bhqk", q, k) * (Dh ** -0.5)
        p = _softmax(scores, axis=-1)
        o = torch.einsum("bhqk,bhkd->bhqd", p, v)
        return (lambda x, *d: x.permute(*d))(o, 0, 2, 1, 3).reshape(B, Sq, Hq * Dh) @ wo

    def _B_ref(x, w_gate, w_up, w_down):
        return (_gelu(x @ w_gate) * (x @ w_up)) @ w_down

    x = A_x
    xn = _layernorm(x, axis=-1)
    return x + _A_ref(xn, A_k_cache, A_v_cache, A_wq, A_wo) + _B_ref(xn, B_w_gate, B_w_up, B_w_down)
```

```asm
; @launch grid=(256,1,1) block=(640,1,1) lds=16384
.amdgcn_target "amdgcn-amd-amdhsa--gfx950"
.text
.globl parallel_sum__sliding_block_cached__geglu_ffn__decode_kernel
.p2align 8
.type parallel_sum__sliding_block_cached__geglu_ffn__decode_kernel,@function
parallel_sum__sliding_block_cached__geglu_ffn__decode_kernel:
    s_cmp_ge_u32 s2, 256
    s_cbranch_scc1 L_EXIT
    s_load_dwordx16 s[8:23], s[0:1], 0
    s_load_dwordx8 s[24:31], s[0:1], 64
    v_lshrrev_b32 v1, 6, v0
    v_and_b32 v0, 63, v0
    v_readfirstlane_b32 s3, v1
    s_lshr_b32 s5, s2, 3
    s_cmp_lg_u32 s3, 9
    s_cbranch_scc1 L_NOCPF
    s_lshr_b32 s6, 503316480, s5
    s_bitcmp1_b32 s6, 0
    s_cbranch_scc0 L_NOCPF
    s_getpc_b64 s[6:7]
L_CPF0:
    v_lshlrev_b32 v1, 4, v0
    s_and_b32 s4, s5, 3
    s_mul_i32 s4, s4, 3072
    v_add_u32 v1, s4, v1
    v_min_u32 v2, L_EXIT-L_CPF0-16, v1
    global_load_dwordx4 v[164:167], v2, s[6:7] offset:0
    v_min_u32 v2, L_EXIT-L_CPF0-1040, v1
    global_load_dwordx4 v[164:167], v2, s[6:7] offset:1024
    v_min_u32 v2, L_EXIT-L_CPF0-2064, v1
    global_load_dwordx4 v[164:167], v2, s[6:7] offset:2048
L_NOCPF:
    s_and_b32 s4, s2, 7
    v_and_b32 v1, 15, v0
    v_lshrrev_b32 v2, 4, v0
    s_cmp_lg_u32 s3, 0
    s_cbranch_scc1 L_NOTW0
    s_setprio 3
    v_and_b32 v3, 7, v0
    v_lshl_add_u32 v8, v2, 3, v3
    v_mul_u32_u24 v8, 36, v8
    v_bfe_u32 v9, v0, 3, 1
    v_mul_u32_u24 v19, 1152, v9
    v_add_u32 v8, v8, v19
    v_lshrrev_b32 v9, 3, v0
    v_mul_u32_u24 v19, 196608, v9
    v_lshl_add_u32 v19, v3, 4, v19
    s_cmp_lt_u32 s5, 16
    s_cselect_b32 s59, 8, -16
    s_add_u32 s59, s59, s5
    s_cmp_lt_u32 s5, 9
    s_cselect_b32 s59, 63, s59
    s_sub_u32 s61, 3, s4
    s_and_b32 s61, s61, 7
    s_cmp_eq_u32 s61, s5
    s_cselect_b32 s59, 16, s59
    s_mul_i32 s63, s59, 43
    s_lshr_b32 s63, s63, 7
    s_mul_i32 s61, s63, 3
    s_sub_u32 s61, s59, s61
    s_mul_i32 s62, s61, 1572864
    s_lshl_b32 s64, s4, 3
    s_add_u32 s63, s63, s64
    s_lshl_b32 s64, s63, 7
    s_add_u32 s62, s62, s64
    s_mov_b32 s34, 2304
    s_mov_b32 s35, 0x20000
    s_mov_b32 s38, 4718592
    s_mov_b32 s39, 0x20000
    s_waitcnt lgkmcnt(0)
    s_mov_b32 s32, s8
    s_and_b32 s33, s9, 0xffff
    buffer_load_dwordx4 v[10:13], v8, s[32:35], 0 offen
    buffer_load_dwordx4 v[14:17], v8, s[32:35], 0 offen offset:16
    buffer_load_dword v18, v8, s[32:35], 0 offen offset:32
    s_load_dword s52, s[30:31], 0
    s_mov_b32 s36, s14
    s_and_b32 s37, s15, 0xffff
    s_cmp_ge_u32 s59, 24
    s_cbranch_scc1 L_NOWQ
    buffer_load_dwordx4 v[72:75], v19, s[36:39], s62 offen nt
    s_addk_i32 s62, 8192
    buffer_load_dwordx4 v[76:79], v19, s[36:39], s62 offen nt
    s_addk_i32 s62, 8192
    buffer_load_dwordx4 v[80:83], v19, s[36:39], s62 offen nt
    s_addk_i32 s62, 8192
    buffer_load_dwordx4 v[84:87], v19, s[36:39], s62 offen nt
    s_addk_i32 s62, 8192
    buffer_load_dwordx4 v[88:91], v19, s[36:39], s62 offen nt
    s_addk_i32 s62, 8192
    buffer_load_dwordx4 v[92:95], v19, s[36:39], s62 offen nt
    s_addk_i32 s62, 8192
    buffer_load_dwordx4 v[96:99], v19, s[36:39], s62 offen nt
    s_addk_i32 s62, 8192
    buffer_load_dwordx4 v[100:103], v19, s[36:39], s62 offen nt
    s_addk_i32 s62, 8192
    buffer_load_dwordx4 v[104:107], v19, s[36:39], s62 offen nt
    s_addk_i32 s62, 8192
    buffer_load_dwordx4 v[108:111], v19, s[36:39], s62 offen nt
    s_addk_i32 s62, 8192
    buffer_load_dwordx4 v[112:115], v19, s[36:39], s62 offen nt
    s_addk_i32 s62, 8192
    buffer_load_dwordx4 v[116:119], v19, s[36:39], s62 offen nt
    s_addk_i32 s62, 8192
    buffer_load_dwordx4 v[120:123], v19, s[36:39], s62 offen nt
    s_addk_i32 s62, 8192
    buffer_load_dwordx4 v[124:127], v19, s[36:39], s62 offen nt
    s_addk_i32 s62, 8192
    buffer_load_dwordx4 v[128:131], v19, s[36:39], s62 offen nt
    s_addk_i32 s62, 8192
    buffer_load_dwordx4 v[132:135], v19, s[36:39], s62 offen nt
    s_addk_i32 s62, 8192
    buffer_load_dwordx4 v[136:139], v19, s[36:39], s62 offen nt
    s_addk_i32 s62, 8192
    buffer_load_dwordx4 v[140:143], v19, s[36:39], s62 offen nt
    s_addk_i32 s62, 8192
    buffer_load_dwordx4 v[144:147], v19, s[36:39], s62 offen nt
    s_addk_i32 s62, 8192
    buffer_load_dwordx4 v[148:151], v19, s[36:39], s62 offen nt
    s_addk_i32 s62, 8192
    buffer_load_dwordx4 v[152:155], v19, s[36:39], s62 offen nt
    s_addk_i32 s62, 8192
    buffer_load_dwordx4 v[156:159], v19, s[36:39], s62 offen nt
    s_addk_i32 s62, 8192
    buffer_load_dwordx4 v[160:163], v19, s[36:39], s62 offen nt
    s_addk_i32 s62, 8192
    buffer_load_dwordx4 v[164:167], v19, s[36:39], s62 offen nt
    s_barrier
    s_branch L_W0R
L_NOWQ:
    s_barrier
    s_mov_b32 s61, 0
    s_waitcnt vmcnt(0)
    s_branch L_W0R
L_EXIT0:
    s_endpgm
L_NOTW0:
    s_sub_u32 s57, s3, 1
    s_sub_u32 s61, s5, 9
    s_cmp_ge_u32 s61, 20
    s_cbranch_scc1 L_FFN
    s_sub_u32 s55, s5, 9
    s_and_b32 s53, s55, 3
    s_lshr_b32 s55, s55, 2
    s_lshr_b32 s54, s53, 1
    s_lshl_b32 s54, s54, 3
    s_add_u32 s54, s54, s4
    s_lshl_b32 s54, s54, 1
    s_and_b32 s56, s53, 1
    s_add_u32 s54, s54, s56
    s_mul_i32 s62, s57, 3
    s_mul_i32 s63, s55, 26
    s_add_u32 s63, s63, s62
    s_cmp_ge_u32 s63, 128
    s_cbranch_scc1 L_ASP0
    s_lshl_b32 s64, s54, 20
    s_add_u32 s64, s64, 786432
    s_lshl_b32 s65, s63, 11
    s_add_u32 s64, s64, s65
    s_add_u32 s65, s64, 4096
    s_cmp_lt_u32 s57, 8
    s_cselect_b32 s65, s65, 2130706432
    s_cselect_b32 s67, 0, 0xf149f2ca
    v_lshrrev_b32 v8, 1, v1
    v_lshlrev_b32 v8, 8, v8
    v_and_b32 v9, 1, v0
    v_lshl_add_u32 v8, v9, 6, v8
    v_lshl_add_u32 v8, v2, 4, v8
    v_lshlrev_b32 v10, 9, v2
    v_lshl_add_u32 v10, v1, 4, v10
    v_add_u32 v9, s65, v8
    v_add_u32 v8, s64, v8
    v_add_u32 v11, s65, v10
    v_add_u32 v10, s64, v10
    s_mov_b32 s34, 33554432
    s_mov_b32 s35, 0x20000
    s_mov_b32 s38, 33554432
    s_mov_b32 s39, 0x20000
    s_waitcnt lgkmcnt(0)
    s_mov_b32 s32, s10
    s_and_b32 s33, s11, 0xffff
    s_mov_b32 s36, s12
    s_and_b32 s37, s13, 0xffff
    s_barrier
    buffer_load_dwordx4 v[16:19], v8, s[32:35], 0 offen offset:0 nt
    buffer_load_dwordx4 v[20:23], v8, s[32:35], 0 offen offset:128 nt
    buffer_load_dwordx4 v[24:27], v8, s[32:35], 0 offen offset:2048 nt
    buffer_load_dwordx4 v[28:31], v8, s[32:35], 0 offen offset:2176 nt
    s_branch L_ATT
L_ASP0:
    s_barrier
    s_branch L_ASPARE
L_FFN:
    s_mul_i32 s56, s4, 9
    s_cmp_lt_u32 s5, 9
    s_cselect_b32 s61, s5, 0
    s_add_u32 s56, s56, s61
    s_mul_i32 s61, s57, 589824
    s_lshl_b32 s62, s56, 7
    s_add_u32 s61, s61, s62
    v_mul_u32_u24 v12, 147456, v2
    v_and_b32 v13, 7, v0
    v_lshl_add_u32 v12, v13, 4, v12
    v_add_u32 v12, s61, v12
    v_mov_b32 v13, 0
    v_cmp_gt_u32 vcc, 8, v1
    s_mov_b32 s64, 9216
    s_mov_b32 s65, 0
    s_waitcnt lgkmcnt(0)
    v_mov_b32 v14, s22
    v_mov_b32 v15, s23
    v_mov_b32 v16, s20
    v_mov_b32 v17, s21
    v_cndmask_b32 v14, v14, v16, vcc
    v_cndmask_b32 v15, v15, v17, vcc
    v_lshl_add_u64 v[14:15], v[12:13], 0, v[14:15]
    s_cmp_ge_u32 s5, 29
    s_cbranch_scc1 L_HELP
    s_barrier
    global_load_dwordx4 v[32:35], v[14:15], off nt
    v_lshl_add_u64 v[14:15], v[14:15], 0, s[64:65]
    global_load_dwordx4 v[36:39], v[14:15], off nt
    v_lshl_add_u64 v[14:15], v[14:15], 0, s[64:65]
    global_load_dwordx4 v[40:43], v[14:15], off nt
    v_lshl_add_u64 v[14:15], v[14:15], 0, s[64:65]
    s_branch L_FFN2
L_HELP:
    s_sub_u32 s61, s5, 29
    s_sub_u32 s62, 3, s4
    s_and_b32 s62, s62, 7
    s_lshl_b32 s62, s62, 7
    s_add_u32 s63, s61, 4
    s_mul_i32 s63, s63, 9216
    s_add_u32 s64, s62, s63
    v_lshl_add_u64 v[18:19], v[14:15], 0, s[64:65]
    s_mov_b32 s64, 27648
    s_barrier
    s_cmp_eq_u32 s4, 3
    s_cbranch_scc1 L_H3X
    global_load_dwordx4 v[20:23], v[18:19], off
    v_lshl_add_u64 v[18:19], v[18:19], 0, s[64:65]
    global_load_dwordx4 v[20:23], v[18:19], off
    v_lshl_add_u64 v[18:19], v[18:19], 0, s[64:65]
    global_load_dwordx4 v[20:23], v[18:19], off
    v_lshl_add_u64 v[18:19], v[18:19], 0, s[64:65]
    s_waitcnt vmcnt(2)
    global_load_dwordx4 v[20:23], v[18:19], off
    s_branch L_H3D
L_H3X:
    global_load_dwordx4 v[20:23], v[18:19], off
    global_load_dwordx4 v[20:23], v[18:19], off offset:1024
    v_lshl_add_u64 v[18:19], v[18:19], 0, s[64:65]
    global_load_dwordx4 v[20:23], v[18:19], off
    s_waitcnt vmcnt(2)
    global_load_dwordx4 v[20:23], v[18:19], off offset:1024
    v_lshl_add_u64 v[18:19], v[18:19], 0, s[64:65]
    s_waitcnt vmcnt(2)
    global_load_dwordx4 v[20:23], v[18:19], off
    s_waitcnt vmcnt(2)
    global_load_dwordx4 v[20:23], v[18:19], off offset:1024
    v_lshl_add_u64 v[18:19], v[18:19], 0, s[64:65]
    s_waitcnt vmcnt(2)
    global_load_dwordx4 v[20:23], v[18:19], off
    s_waitcnt vmcnt(2)
    global_load_dwordx4 v[20:23], v[18:19], off offset:1024
L_H3D:
    v_lshrrev_b32 v8, 3, v0
    v_mul_u32_u24 v124, 9216, v8
    v_and_b32 v8, 7, v0
    v_lshl_add_u32 v124, v8, 4, v124
    s_mov_b32 s32, s24
    s_and_b32 s33, s25, 0xffff
    s_mov_b32 s34, 5308416
    s_mov_b32 s35, 0x20000
    s_load_dword s52, s[30:31], 0
    s_mul_i32 s62, s57, 171
    s_lshr_b32 s62, s62, 9
    s_mul_i32 s61, s61, 3
    s_add_u32 s56, s56, s61
    s_add_u32 s56, s56, s62
    s_mul_i32 s62, s62, 3
    s_sub_u32 s57, s57, s62
    s_add_u32 s57, s57, 6
    s_cmp_eq_u32 s4, 3
    s_cselect_b32 s61, 8, 7
    s_cmp_lt_u32 s57, s61
    s_cbranch_scc1 L_NOJOB
    s_add_u32 s58, s56, 64
    s_mov_b32 s19, 1
    s_mul_i32 s61, s56, 73728
    s_lshl_b32 s62, s57, 7
    s_add_u32 s61, s61, s62
    s_waitcnt vmcnt(3)
    buffer_load_dwordx4 v[132:135], v124, s[32:35], s61 offen offset:0 nt
    s_waitcnt vmcnt(3)
    buffer_load_dwordx4 v[136:139], v124, s[32:35], s61 offen offset:1152 nt
    s_waitcnt vmcnt(3)
    buffer_load_dwordx4 v[140:143], v124, s[32:35], s61 offen offset:2304 nt
    s_waitcnt vmcnt(3)
    buffer_load_dwordx4 v[144:147], v124, s[32:35], s61 offen offset:3456 nt
    s_waitcnt vmcnt(3)
    s_add_u32 s61, s61, 4608
    buffer_load_dwordx4 v[148:151], v124, s[32:35], s61 offen offset:0 nt
    s_waitcnt vmcnt(3)
    buffer_load_dwordx4 v[152:155], v124, s[32:35], s61 offen offset:1152 nt
    s_waitcnt vmcnt(3)
    buffer_load_dwordx4 v[156:159], v124, s[32:35], s61 offen offset:2304 nt
    s_waitcnt vmcnt(3)
    buffer_load_dwordx4 v[160:163], v124, s[32:35], s61 offen offset:3456 nt
    s_waitcnt vmcnt(8) lgkmcnt(0)
    s_branch L_TAIL
L_ASPARE:
    s_waitcnt lgkmcnt(0)
    s_load_dword s52, s[30:31], 0
    s_lshl_b32 s56, s4, 2
    s_add_u32 s56, s56, s53
    s_lshl_b32 s56, s56, 1
    s_mov_b32 s44, s30
    s_and_b32 s45, s31, 0xffff
    s_mov_b32 s46, 4194304
    s_mov_b32 s47, 0x20000
    s_add_u32 s56, s56, 1
    s_mov_b32 s18, 512
    s_mov_b32 s19, 0
    s_setprio 3
    s_waitcnt lgkmcnt(0)
    s_add_u32 s48, s52, 1
    s_and_b32 s48, s48, 0xff
    s_add_u32 s49, s52, 72
    s_and_b32 s49, s49, 0xff
    s_add_u32 s50, s52, 142
    s_and_b32 s50, s50, 0xff
    s_add_u32 s51, s52, 215
    s_and_b32 s51, s51, 0xff
    v_bfe_u32 v33, v0, 4, 1
    v_mul_u32_u24 v34, 1280, v33
    v_lshl_add_u32 v34, v1, 4, v34
    v_mul_u32_u24 v33, 640, v33
    s_mul_i32 s66, s56, 2560
    s_add_u32 s66, s66, 659456
    s_lshr_b32 s67, s56, 1
    s_mul_i32 s67, s67, 1280
    s_add_u32 s67, s67, 823296
    v_add_u32 v34, s66, v34
    v_add_u32 v33, s67, v33
    v_cmp_gt_u32 vcc, 32, v0
    v_mov_b32 v37, 0x100
    s_nop 0
    v_cndmask_b32 v32, v33, v34, vcc
    v_mov_b32 v38, 0x80
    v_cndmask_b32 v37, v38, v37, vcc
    v_add_u32 v33, v32, v37
    v_add_u32 v34, v33, v37
    v_add_u32 v35, v34, v37
    v_add_u32 v36, v35, v37
    s_mov_b32 s66, 0x3fb8aa3b
    v_lshlrev_b32 v37, 4, v0
    v_add_u32 v37, s18, v37
    s_lshr_b32 s67, s18, 7
    v_mov_b32 v38, s67
    v_mov_b32 v39, 1
    v_lshlrev_b32 v8, 4, v0
    v_mov_b32 v12, 0
    v_mov_b32 v13, 0
    v_mov_b32 v14, 0
    v_mov_b32 v15, 0
    v_mov_b32 v10, 0xf149f2ca
    v_mov_b32 v11, 1.0
    ds_write_b128 v8, v[12:15] offset:15360
    s_barrier
    ds_write_b64 v12, v[10:11] offset:5184
    ds_write_b64 v12, v[10:11] offset:5312
    s_waitcnt lgkmcnt(0)
    s_barrier
    s_mov_b32 s59, 0
L_SPW:
    ds_read_b32 v11, v12 offset:5640
    s_add_u32 s59, s59, 1
    s_cmp_lt_u32 s59, 0x100000
    s_waitcnt lgkmcnt(0)
    s_cbranch_scc0 L_GATHO
    v_cmp_eq_u32 vcc, 0, v11
    s_cbranch_vccnz L_SPW
    s_branch L_GATHO
L_W0R:
    v_and_b32 v38, 1, v0
    v_lshlrev_b32 v38, 4, v38
    v_mov_b32 v39, 0xffff
    v_lshlrev_b32 v38, v38, v39
    v_bfe_u32 v39, v0, 1, 1
    v_cmp_eq_u32 vcc, 0, v39
    s_nop 1
    v_cndmask_b32 v4, 0, v38, vcc
    v_cmp_eq_u32 vcc, 1, v39
    s_nop 1
    v_cndmask_b32 v5, 0, v38, vcc
    s_mov_b32 s44, s30
    s_and_b32 s45, s31, 0xffff
    s_mov_b32 s46, 4194304
    s_mov_b32 s47, 0x20000
    v_mov_b32 v20, 0
    v_mov_b32 v21, 0
    v_mov_b32 v22, 0
    v_mov_b32 v23, 0
    v_lshlrev_b32 v24, 4, v0
    ds_write_b128 v24, v[20:23] offset:5120
    s_mov_b32 s60, 0xffff0000
    v_lshlrev_b32 v8, 1, v8
    v_mul_u32_u24 v9, 96, v9
    v_bfe_u32 v19, v0, 2, 1
    v_mul_u32_u24 v19, 2304, v19
    v_add_u32 v9, v9, v19
    s_mul_i32 s62, s61, 768
    v_add_u32 v9, s62, v9
    s_lshl_b32 s63, s63, 2
    s_add_u32 s61, s61, s63
    s_lshl_b32 s61, s61, 9
    s_add_u32 s61, s61, 4096
    s_mov_b32 s63, 0x3ae38e39
    s_waitcnt vmcnt(24)
    v_lshlrev_b32 v20, 16, v10
    v_and_b32 v21, s60, v10
    v_lshlrev_b32 v22, 16, v11
    v_and_b32 v23, s60, v11
    v_lshlrev_b32 v24, 16, v12
    v_and_b32 v25, s60, v12
    v_lshlrev_b32 v26, 16, v13
    v_and_b32 v27, s60, v13
    v_lshlrev_b32 v28, 16, v14
    v_and_b32 v29, s60, v14
    v_lshlrev_b32 v30, 16, v15
    v_and_b32 v31, s60, v15
    v_lshlrev_b32 v32, 16, v16
    v_and_b32 v33, s60, v16
    v_lshlrev_b32 v34, 16, v17
    v_and_b32 v35, s60, v17
    v_lshlrev_b32 v36, 16, v18
    v_and_b32 v37, s60, v18
    v_pk_add_f32 v[38:39], v[20:21], v[22:23]
    v_pk_add_f32 v[58:59], v[24:25], v[26:27]
    v_pk_add_f32 v[38:39], v[38:39], v[28:29]
    v_pk_add_f32 v[58:59], v[58:59], v[30:31]
    v_pk_add_f32 v[38:39], v[38:39], v[32:33]
    v_pk_add_f32 v[58:59], v[58:59], v[34:35]
    v_pk_add_f32 v[38:39], v[38:39], v[36:37]
    v_pk_add_f32 v[38:39], v[38:39], v[58:59]
    v_add_f32 v38, v38, v39
    s_nop 1
    v_add_f32 v38, v38, v38 quad_perm:[1,0,3,2] row_mask:0xf bank_mask:0xf
    s_nop 1
    v_add_f32 v38, v38, v38 quad_perm:[2,3,0,1] row_mask:0xf bank_mask:0xf
    s_nop 1
    v_add_f32 v38, v38, v38 row_half_mirror row_mask:0xf bank_mask:0xf
    v_mov_b32 v39, v38
    s_nop 1
    v_permlane16_swap_b32 v38, v39
    v_add_f32 v38, v38, v39
    v_mov_b32 v39, v38
    s_nop 1
    v_permlane32_swap_b32 v38, v39
    v_add_f32 v38, v38, v39
    v_mul_f32 v38, s63, v38
    v_pk_add_f32 v[40:41], v[20:21], v[38:39] op_sel_hi:[1,0] neg_lo:[0,1] neg_hi:[0,1]
    v_pk_add_f32 v[42:43], v[22:23], v[38:39] op_sel_hi:[1,0] neg_lo:[0,1] neg_hi:[0,1]
    v_pk_add_f32 v[44:45], v[24:25], v[38:39] op_sel_hi:[1,0] neg_lo:[0,1] neg_hi:[0,1]
    v_pk_add_f32 v[46:47], v[26:27], v[38:39] op_sel_hi:[1,0] neg_lo:[0,1] neg_hi:[0,1]
    v_pk_add_f32 v[48:49], v[28:29], v[38:39] op_sel_hi:[1,0] neg_lo:[0,1] neg_hi:[0,1]
    v_pk_add_f32 v[50:51], v[30:31], v[38:39] op_sel_hi:[1,0] neg_lo:[0,1] neg_hi:[0,1]
    v_pk_add_f32 v[52:53], v[32:33], v[38:39] op_sel_hi:[1,0] neg_lo:[0,1] neg_hi:[0,1]
    v_pk_add_f32 v[54:55], v[34:35], v[38:39] op_sel_hi:[1,0] neg_lo:[0,1] neg_hi:[0,1]
    v_pk_add_f32 v[56:57], v[36:37], v[38:39] op_sel_hi:[1,0] neg_lo:[0,1] neg_hi:[0,1]
    v_pk_mul_f32 v[58:59], v[40:41], v[40:41]
    v_pk_fma_f32 v[58:59], v[42:43], v[42:43], v[58:59]
    v_pk_fma_f32 v[58:59], v[44:45], v[44:45], v[58:59]
    v_pk_fma_f32 v[58:59], v[46:47], v[46:47], v[58:59]
    v_pk_fma_f32 v[58:59], v[48:49], v[48:49], v[58:59]
    v_pk_fma_f32 v[58:59], v[50:51], v[50:51], v[58:59]
    v_pk_fma_f32 v[58:59], v[52:53], v[52:53], v[58:59]
    v_pk_fma_f32 v[58:59], v[54:55], v[54:55], v[58:59]
    v_pk_fma_f32 v[58:59], v[56:57], v[56:57], v[58:59]
    v_add_f32 v58, v58, v59
    v_cvt_pk_bf16_f32 v38, v38, v38
    v_and_b32 v38, s60, v38
    v_add_f32 v58, v58, v58 quad_perm:[1,0,3,2] row_mask:0xf bank_mask:0xf
    v_pk_add_f32 v[40:41], v[20:21], v[38:39] op_sel_hi:[1,0] neg_lo:[0,1] neg_hi:[0,1]
    v_pk_add_f32 v[42:43], v[22:23], v[38:39] op_sel_hi:[1,0] neg_lo:[0,1] neg_hi:[0,1]
    v_add_f32 v58, v58, v58 quad_perm:[2,3,0,1] row_mask:0xf bank_mask:0xf
    v_pk_add_f32 v[44:45], v[24:25], v[38:39] op_sel_hi:[1,0] neg_lo:[0,1] neg_hi:[0,1]
    v_pk_add_f32 v[46:47], v[26:27], v[38:39] op_sel_hi:[1,0] neg_lo:[0,1] neg_hi:[0,1]
    v_add_f32 v58, v58, v58 row_half_mirror row_mask:0xf bank_mask:0xf
    v_pk_add_f32 v[48:49], v[28:29], v[38:39] op_sel_hi:[1,0] neg_lo:[0,1] neg_hi:[0,1]
    v_pk_add_f32 v[50:51], v[30:31], v[38:39] op_sel_hi:[1,0] neg_lo:[0,1] neg_hi:[0,1]
    v_mov_b32 v59, v58
    v_pk_add_f32 v[52:53], v[32:33], v[38:39] op_sel_hi:[1,0] neg_lo:[0,1] neg_hi:[0,1]
    v_pk_add_f32 v[54:55], v[34:35], v[38:39] op_sel_hi:[1,0] neg_lo:[0,1] neg_hi:[0,1]
    v_permlane16_swap_b32 v58, v59
    v_pk_add_f32 v[56:57], v[36:37], v[38:39] op_sel_hi:[1,0] neg_lo:[0,1] neg_hi:[0,1]
    v_cvt_pk_bf16_f32 v10, v40, v41
    v_add_f32 v58, v58, v59
    v_cvt_pk_bf16_f32 v11, v42, v43
    v_cvt_pk_bf16_f32 v12, v44, v45
    v_mov_b32 v59, v58
    v_cvt_pk_bf16_f32 v13, v46, v47
    v_cvt_pk_bf16_f32 v14, v48, v49
    v_permlane32_swap_b32 v58, v59
    v_cvt_pk_bf16_f32 v15, v50, v51
    v_cvt_pk_bf16_f32 v16, v52, v53
    v_add_f32 v58, v58, v59
    v_cvt_pk_bf16_f32 v17, v54, v55
    v_cvt_pk_bf16_f32 v18, v56, v57
    v_mul_f32 v58, s63, v58
    v_lshlrev_b32 v20, 16, v10
    v_and_b32 v21, s60, v10
    v_cvt_pk_bf16_f32 v58, v58, v58
    v_lshlrev_b32 v22, 16, v11
    v_and_b32 v23, s60, v11
    v_and_b32 v58, s60, v58
    v_lshlrev_b32 v24, 16, v12
    v_and_b32 v25, s60, v12
    v_add_f32 v58, 0x3727c5ac, v58
    v_lshlrev_b32 v26, 16, v13
    v_and_b32 v27, s60, v13
    v_cvt_pk_bf16_f32 v58, v58, v58
    v_lshlrev_b32 v28, 16, v14
    v_and_b32 v29, s60, v14
    v_and_b32 v58, s60, v58
    v_lshlrev_b32 v30, 16, v15
    v_and_b32 v31, s60, v15
    v_sqrt_f32 v58, v58
    v_lshlrev_b32 v32, 16, v16
    v_and_b32 v33, s60, v16
    v_cvt_pk_bf16_f32 v58, v58, v58
    v_lshlrev_b32 v34, 16, v17
    v_and_b32 v35, s60, v17
    v_and_b32 v58, s60, v58
    v_lshlrev_b32 v36, 16, v18
    v_and_b32 v37, s60, v18
    v_rcp_f32 v58, v58
    s_nop 0
    v_pk_mul_f32 v[20:21], v[20:21], v[58:59] op_sel_hi:[1,0]
    v_pk_mul_f32 v[22:23], v[22:23], v[58:59] op_sel_hi:[1,0]
    v_pk_mul_f32 v[24:25], v[24:25], v[58:59] op_sel_hi:[1,0]
    v_pk_mul_f32 v[26:27], v[26:27], v[58:59] op_sel_hi:[1,0]
    v_pk_mul_f32 v[28:29], v[28:29], v[58:59] op_sel_hi:[1,0]
    v_pk_mul_f32 v[30:31], v[30:31], v[58:59] op_sel_hi:[1,0]
    v_pk_mul_f32 v[32:33], v[32:33], v[58:59] op_sel_hi:[1,0]
    v_pk_mul_f32 v[34:35], v[34:35], v[58:59] op_sel_hi:[1,0]
    v_pk_mul_f32 v[36:37], v[36:37], v[58:59] op_sel_hi:[1,0]
    v_cvt_pk_bf16_f32 v40, v20, v20
    v_cvt_pk_bf16_f32 v41, v21, v21
    v_cvt_pk_bf16_f32 v42, v22, v22
    v_cvt_pk_bf16_f32 v43, v23, v23
    ds_write2_b64 v8, v[40:41], v[42:43] offset0:0 offset1:1
    v_cvt_pk_bf16_f32 v44, v24, v24
    v_cvt_pk_bf16_f32 v45, v25, v25
    v_cvt_pk_bf16_f32 v46, v26, v26
    v_cvt_pk_bf16_f32 v47, v27, v27
    ds_write2_b64 v8, v[44:45], v[46:47] offset0:2 offset1:3
    v_cvt_pk_bf16_f32 v48, v28, v28
    v_cvt_pk_bf16_f32 v49, v29, v29
    v_cvt_pk_bf16_f32 v50, v30, v30
    v_cvt_pk_bf16_f32 v51, v31, v31
    ds_write2_b64 v8, v[48:49], v[50:51] offset0:4 offset1:5
    v_cvt_pk_bf16_f32 v52, v32, v32
    v_cvt_pk_bf16_f32 v53, v33, v33
    v_cvt_pk_bf16_f32 v54, v34, v34
    v_cvt_pk_bf16_f32 v55, v35, v35
    ds_write2_b64 v8, v[52:53], v[54:55] offset0:6 offset1:7
    v_cvt_pk_bf16_f32 v56, v36, v36
    v_cvt_pk_bf16_f32 v57, v37, v37
    ds_write_b64 v8, v[56:57] offset:64
    ds_read_b128 v[20:23], v9 offset:0
    ds_read_b128 v[24:27], v9 offset:16
    ds_read_b128 v[28:31], v9 offset:32
    ds_read_b128 v[32:35], v9 offset:48
    ds_read_b128 v[36:39], v9 offset:64
    ds_read_b128 v[40:43], v9 offset:80
    v_and_b32 v8, 1, v2
    v_lshlrev_b32 v8, 8, v8
    v_lshl_add_u32 v8, v3, 5, v8
    v_lshrrev_b32 v9, 5, v0
    v_lshl_add_u32 v8, v9, 4, v8
    v_mov_b32 v3, 0xff
    s_waitcnt lgkmcnt(0)
    s_add_u32 s48, s52, 1
    s_and_b32 s48, s48, 0xff
    s_add_u32 s49, s52, 72
    s_and_b32 s49, s49, 0xff
    s_add_u32 s50, s52, 142
    s_and_b32 s50, s50, 0xff
    s_add_u32 s51, s52, 215
    s_and_b32 s51, s51, 0xff
    s_cmp_ge_u32 s59, 24
    s_cbranch_scc1 L_W0F
    v_and_b32 v48, v4, v20
    v_and_b32 v49, v5, v20
    v_and_b32 v50, v4, v21
    v_and_b32 v51, v5, v21
    s_waitcnt vmcnt(22)
    v_swap_b32 v74, v76
    v_swap_b32 v75, v77
    v_and_b32 v52, v4, v22
    v_and_b32 v53, v5, v22
    v_and_b32 v54, v4, v23
    v_and_b32 v55, v5, v23
    s_waitcnt vmcnt(20)
    v_swap_b32 v82, v84
    v_swap_b32 v83, v85
    v_mfma_f32_16x16x32_bf16 v[64:67], v[48:51], v[72:75], 0
    v_mfma_f32_16x16x32_bf16 v[68:71], v[48:51], v[76:79], 0
    v_and_b32 v48, v4, v24
    v_and_b32 v49, v5, v24
    v_and_b32 v50, v4, v25
    v_and_b32 v51, v5, v25
    s_waitcnt vmcnt(18)
    v_swap_b32 v90, v92
    v_swap_b32 v91, v93
    v_mfma_f32_16x16x32_bf16 v[64:67], v[52:55], v[80:83], v[64:67]
    v_mfma_f32_16x16x32_bf16 v[68:71], v[52:55], v[84:87], v[68:71]
    v_and_b32 v52, v4, v26
    v_and_b32 v53, v5, v26
    v_and_b32 v54, v4, v27
    v_and_b32 v55, v5, v27
    s_waitcnt vmcnt(16)
    v_swap_b32 v98, v100
    v_swap_b32 v99, v101
    v_mfma_f32_16x16x32_bf16 v[64:67], v[48:51], v[88:91], v[64:67]
    v_mfma_f32_16x16x32_bf16 v[68:71], v[48:51], v[92:95], v[68:71]
    v_and_b32 v48, v4, v28
    v_and_b32 v49, v5, v28
    v_and_b32 v50, v4, v29
    v_and_b32 v51, v5, v29
    s_waitcnt vmcnt(14)
    v_swap_b32 v106, v108
    v_swap_b32 v107, v109
    v_mfma_f32_16x16x32_bf16 v[64:67], v[52:55], v[96:99], v[64:67]
    v_mfma_f32_16x16x32_bf16 v[68:71], v[52:55], v[100:103], v[68:71]
    v_and_b32 v52, v4, v30
    v_and_b32 v53, v5, v30
    v_and_b32 v54, v4, v31
    v_and_b32 v55, v5, v31
    s_waitcnt vmcnt(12)
    v_swap_b32 v114, v116
    v_swap_b32 v115, v117
    v_mfma_f32_16x16x32_bf16 v[64:67], v[48:51], v[104:107], v[64:67]
    v_mfma_f32_16x16x32_bf16 v[68:71], v[48:51], v[108:111], v[68:71]
    v_and_b32 v48, v4, v32
    v_and_b32 v49, v5, v32
    v_and_b32 v50, v4, v33
    v_and_b32 v51, v5, v33
    s_waitcnt vmcnt(10)
    v_swap_b32 v122, v124
    v_swap_b32 v123, v125
    v_mfma_f32_16x16x32_bf16 v[64:67], v[52:55], v[112:115], v[64:67]
    v_mfma_f32_16x16x32_bf16 v[68:71], v[52:55], v[116:119], v[68:71]
    v_and_b32 v52, v4, v34
    v_and_b32 v53, v5, v34
    v_and_b32 v54, v4, v35
    v_and_b32 v55, v5, v35
    s_waitcnt vmcnt(8)
    v_swap_b32 v130, v132
    v_swap_b32 v131, v133
    v_mfma_f32_16x16x32_bf16 v[64:67], v[48:51], v[120:123], v[64:67]
    v_mfma_f32_16x16x32_bf16 v[68:71], v[48:51], v[124:127], v[68:71]
    v_and_b32 v48, v4, v36
    v_and_b32 v49, v5, v36
    v_and_b32 v50, v4, v37
    v_and_b32 v51, v5, v37
    s_waitcnt vmcnt(6)
    v_swap_b32 v138, v140
    v_swap_b32 v139, v141
    v_mfma_f32_16x16x32_bf16 v[64:67], v[52:55], v[128:131], v[64:67]
    v_mfma_f32_16x16x32_bf16 v[68:71], v[52:55], v[132:135], v[68:71]
    v_and_b32 v52, v4, v38
    v_and_b32 v53, v5, v38
    v_and_b32 v54, v4, v39
    v_and_b32 v55, v5, v39
    s_waitcnt vmcnt(4)
    v_swap_b32 v146, v148
    v_swap_b32 v147, v149
    v_mfma_f32_16x16x32_bf16 v[64:67], v[48:51], v[136:139], v[64:67]
    v_mfma_f32_16x16x32_bf16 v[68:71], v[48:51], v[140:143], v[68:71]
    v_and_b32 v48, v4, v40
    v_and_b32 v49, v5, v40
    v_and_b32 v50, v4, v41
    v_and_b32 v51, v5, v41
    s_waitcnt vmcnt(2)
    v_swap_b32 v154, v156
    v_swap_b32 v155, v157
    v_mfma_f32_16x16x32_bf16 v[64:67], v[52:55], v[144:147], v[64:67]
    v_mfma_f32_16x16x32_bf16 v[68:71], v[52:55], v[148:151], v[68:71]
    v_and_b32 v52, v4, v42
    v_and_b32 v53, v5, v42
    v_and_b32 v54, v4, v43
    v_and_b32 v55, v5, v43
    s_waitcnt vmcnt(0)
    v_swap_b32 v162, v164
    v_swap_b32 v163, v165
    v_mfma_f32_16x16x32_bf16 v[64:67], v[48:51], v[152:155], v[64:67]
    v_mfma_f32_16x16x32_bf16 v[68:71], v[48:51], v[156:159], v[68:71]
    v_mfma_f32_16x16x32_bf16 v[64:67], v[52:55], v[160:163], v[64:67]
    v_mfma_f32_16x16x32_bf16 v[68:71], v[52:55], v[164:167], v[68:71]
    s_nop 7
    v_permlane32_swap_b32 v64, v68
    v_permlane32_swap_b32 v65, v69
    v_permlane32_swap_b32 v66, v70
    v_permlane32_swap_b32 v67, v71
    v_add_f32 v64, v68, v64 row_ror:8 row_mask:0xf bank_mask:0xf
    v_add_f32 v65, v69, v65 row_ror:8 row_mask:0xf bank_mask:0xf
    v_add_f32 v66, v70, v66 row_ror:8 row_mask:0xf bank_mask:0xf
    v_add_f32 v67, v71, v67 row_ror:8 row_mask:0xf bank_mask:0xf
    v_bfi_b32 v64, 7, s48, v64
    v_bfi_b32 v65, 7, s49, v65
    v_bfi_b32 v66, 7, s50, v66
    v_bfi_b32 v67, 7, s51, v67
    s_mov_b32 exec_lo, 0x00ff00ff
    s_mov_b32 exec_hi, 0x00ff00ff
    s_add_u32 s69, s61, 524288
    buffer_store_dwordx4 v[64:67], v8, s[44:47], s69 offen
    buffer_store_dwordx4 v[64:67], v8, s[44:47], s61 offen sc1
    s_mov_b64 exec, -1
    s_cmp_lt_u32 s5, 9
    s_cbranch_scc1 L_W0F
    s_cmp_ge_u32 s5, 29
    s_cbranch_scc1 L_W0END
    s_sub_u32 s55, s5, 9
    s_and_b32 s53, s55, 3
    s_lshr_b32 s55, s55, 2
    s_lshr_b32 s54, s53, 1
    s_lshl_b32 s54, s54, 3
    s_add_u32 s54, s54, s4
    s_lshl_b32 s54, s54, 1
    s_and_b32 s56, s53, 1
    s_add_u32 s54, s54, s56
    v_lshlrev_b32 v9, 11, v2
    v_lshl_add_u32 v9, v1, 4, v9
    s_and_b32 s61, s54, 15
    s_lshl_b32 s62, s61, 13
    s_lshr_b32 s63, s54, 4
    s_lshl_b32 s64, s63, 8
    s_add_u32 s62, s62, s64
    s_add_u32 s62, s62, 4096
    v_lshlrev_b32 v10, 3, v0
    s_and_b32 s20, s48, 7
    s_and_b32 s21, s49, 7
    s_and_b32 s22, s50, 7
    s_and_b32 s23, s51, 7
    v_add_u32 v9, 524288, v9
    s_mov_b32 s59, 0
    buffer_load_dwordx4 v[112:115], v9, s[44:47], s62 offen offset:0 sc1
    buffer_load_dwordx4 v[116:119], v9, s[44:47], s62 offen offset:512 sc1
    buffer_load_dwordx4 v[120:123], v9, s[44:47], s62 offen offset:1024 sc1
    s_sleep 16
    buffer_load_dwordx4 v[52:55], v9, s[44:47], s62 offen offset:0 sc1
    buffer_load_dwordx4 v[56:59], v9, s[44:47], s62 offen offset:512 sc1
    buffer_load_dwordx4 v[60:63], v9, s[44:47], s62 offen offset:1024 sc1
    s_sleep 16
L_q_poll:
    buffer_load_dwordx4 v[148:151], v9, s[44:47], s62 offen offset:0 sc1
    buffer_load_dwordx4 v[152:155], v9, s[44:47], s62 offen offset:512 sc1
    buffer_load_dwordx4 v[156:159], v9, s[44:47], s62 offen offset:1024 sc1
    s_waitcnt vmcnt(8)
    v_xor_b32 v128, s20, v112
    v_xor_b32 v129, s21, v113
    v_xor_b32 v130, s22, v114
    v_xor_b32 v131, s23, v115
    v_or_b32 v11, v128, v129
    v_or3_b32 v11, v11, v130, v131
    s_waitcnt vmcnt(7)
    v_xor_b32 v132, s20, v116
    v_xor_b32 v133, s21, v117
    v_xor_b32 v134, s22, v118
    v_xor_b32 v135, s23, v119
    v_or3_b32 v11, v11, v132, v133
    v_or3_b32 v11, v11, v134, v135
    s_waitcnt vmcnt(6)
    v_xor_b32 v136, s20, v120
    v_xor_b32 v137, s21, v121
    v_xor_b32 v138, s22, v122
    v_xor_b32 v139, s23, v123
    v_or3_b32 v11, v11, v136, v137
    v_or3_b32 v11, v11, v138, v139
    v_and_b32 v11, 7, v11
    v_cmp_ne_u32 vcc, 0, v11
    s_cbranch_vccz L_q_done
    buffer_load_dwordx4 v[112:115], v9, s[44:47], s62 offen offset:0 sc1
    buffer_load_dwordx4 v[116:119], v9, s[44:47], s62 offen offset:512 sc1
    buffer_load_dwordx4 v[120:123], v9, s[44:47], s62 offen offset:1024 sc1
    s_waitcnt vmcnt(8)
    v_xor_b32 v128, s20, v52
    v_xor_b32 v129, s21, v53
    v_xor_b32 v130, s22, v54
    v_xor_b32 v131, s23, v55
    v_or_b32 v11, v128, v129
    v_or3_b32 v11, v11, v130, v131
    s_waitcnt vmcnt(7)
    v_xor_b32 v132, s20, v56
    v_xor_b32 v133, s21, v57
    v_xor_b32 v134, s22, v58
    v_xor_b32 v135, s23, v59
    v_or3_b32 v11, v11, v132, v133
    v_or3_b32 v11, v11, v134, v135
    s_waitcnt vmcnt(6)
    v_xor_b32 v136, s20, v60
    v_xor_b32 v137, s21, v61
    v_xor_b32 v138, s22, v62
    v_xor_b32 v139, s23, v63
    v_or3_b32 v11, v11, v136, v137
    v_or3_b32 v11, v11, v138, v139
    v_and_b32 v11, 7, v11
    v_cmp_ne_u32 vcc, 0, v11
    s_cbranch_vccz L_q_done
    buffer_load_dwordx4 v[52:55], v9, s[44:47], s62 offen offset:0 sc1
    buffer_load_dwordx4 v[56:59], v9, s[44:47], s62 offen offset:512 sc1
    buffer_load_dwordx4 v[60:63], v9, s[44:47], s62 offen offset:1024 sc1
    s_waitcnt vmcnt(8)
    v_xor_b32 v128, s20, v148
    v_xor_b32 v129, s21, v149
    v_xor_b32 v130, s22, v150
    v_xor_b32 v131, s23, v151
    v_or_b32 v11, v128, v129
    v_or3_b32 v11, v11, v130, v131
    s_waitcnt vmcnt(7)
    v_xor_b32 v132, s20, v152
    v_xor_b32 v133, s21, v153
    v_xor_b32 v134, s22, v154
    v_xor_b32 v135, s23, v155
    v_or3_b32 v11, v11, v132, v133
    v_or3_b32 v11, v11, v134, v135
    s_waitcnt vmcnt(6)
    v_xor_b32 v136, s20, v156
    v_xor_b32 v137, s21, v157
    v_xor_b32 v138, s22, v158
    v_xor_b32 v139, s23, v159
    v_or3_b32 v11, v11, v136, v137
    v_or3_b32 v11, v11, v138, v139
    v_and_b32 v11, 7, v11
    v_cmp_ne_u32 vcc, 0, v11
    s_cbranch_vccz L_q_done
    s_add_u32 s59, s59, 1
    s_cmp_lt_u32 s59, 64
    s_cbranch_scc1 L_q_poll
    v_xor_b32 v9, 524288, v9
    s_cmp_lt_u32 s59, 0x18000
    s_cbranch_scc1 L_q_poll
L_q_done:
    v_pk_add_f32 v[128:129], v[128:129], v[132:133]
    v_pk_add_f32 v[130:131], v[130:131], v[134:135]
    v_pk_add_f32 v[16:17], v[128:129], v[136:137]
    v_pk_add_f32 v[18:19], v[130:131], v[138:139]
    v_cvt_pk_bf16_f32 v16, v16, v17
    v_cvt_pk_bf16_f32 v17, v18, v19
    ds_write_b64 v10, v[16:17] offset:4608
    s_waitcnt lgkmcnt(0)
    s_barrier
    v_lshrrev_b32 v9, 5, v0
    v_lshrrev_b32 v10, 3, v1
    v_lshl_add_u32 v10, v9, 1, v10
    v_mul_u32_u24 v10, 2560, v10
    v_and_b32 v11, 7, v0
    v_lshl_add_u32 v10, v11, 5, v10
    v_and_b32 v11, 1, v2
    v_lshl_add_u32 v10, v11, 4, v10
    s_mul_i32 s64, s63, 5
    s_add_u32 s64, s64, s55
    s_mul_i32 s62, s61, 10240
    s_lshl_b32 s65, s64, 8
    s_add_u32 s62, s62, s65
    s_add_u32 s62, s62, 135168
    s_mul_i32 s65, s61, 2560
    s_lshl_b32 s64, s64, 7
    s_add_u32 s65, s65, s64
    s_add_u32 s65, s65, 299008
    v_mul_u32_u24 v14, 1280, v9
    v_and_b32 v11, 7, v0
    v_lshl_add_u32 v14, v11, 4, v14
    v_lshlrev_b32 v12, 7, v9
    v_lshlrev_b32 v13, 4, v0
    s_lshl_b32 s56, s4, 2
    s_add_u32 s56, s56, s53
    s_lshl_b32 s56, s56, 1
    s_bfe_u32 s66, s55, 0x10001
    s_add_u32 s56, s56, s66
    s_mov_b32 s18, 0
    v_mov_b32 v24, s49
    v_mov_b32 v25, s49
    v_mov_b32 v26, s49
    v_mov_b32 v27, s49
    s_add_u32 s69, s62, 524288
    buffer_store_dwordx4 v[24:27], v10, s[44:47], s69 offen
    v_bfe_u32 v33, v0, 4, 1
    v_mul_u32_u24 v34, 1280, v33
    v_lshl_add_u32 v34, v1, 4, v34
    v_mul_u32_u24 v33, 640, v33
    s_mul_i32 s66, s56, 2560
    s_add_u32 s66, s66, 659456
    s_lshr_b32 s67, s56, 1
    s_mul_i32 s67, s67, 1280
    s_add_u32 s67, s67, 823296
    v_add_u32 v34, s66, v34
    v_add_u32 v33, s67, v33
    v_cmp_gt_u32 vcc, 32, v0
    v_mov_b32 v37, 0x100
    s_nop 0
    v_cndmask_b32 v32, v33, v34, vcc
    v_mov_b32 v38, 0x80
    v_cndmask_b32 v37, v38, v37, vcc
    v_add_u32 v33, v32, v37
    v_add_u32 v34, v33, v37
    v_add_u32 v35, v34, v37
    v_add_u32 v36, v35, v37
    s_mov_b32 s66, 0x3fb8aa3b
    v_lshlrev_b32 v37, 4, v0
    v_add_u32 v37, s18, v37
    s_lshr_b32 s67, s18, 7
    v_mov_b32 v38, s67
    v_mov_b32 v39, 1
    s_mov_b32 s59, 0
L_MLP:
    ds_read_b128 v[128:131], v12 offset:5120
    ds_read_b128 v[132:135], v12 offset:5136
    ds_read_b128 v[136:139], v12 offset:5152
    ds_read_b128 v[140:143], v12 offset:5168
    ds_read_b64 v[144:145], v12 offset:5184
    s_add_u32 s59, s59, 1
    s_waitcnt lgkmcnt(0)
    v_min3_u32 v16, v129, v131, v133
    v_min3_u32 v17, v135, v137, v139
    v_min3_u32 v18, v141, v143, v145
    v_min3_u32 v16, v16, v17, v18
    v_cmp_eq_u32 vcc, 0, v16
    s_cbranch_vccz L_MLD
    s_sleep 1
    s_cmp_lt_u32 s59, 0x100000
    s_cbranch_scc1 L_MLP
L_MLD:
    v_max3_f32 v16, v128, v130, v132
    v_max3_f32 v17, v134, v136, v138
    v_max3_f32 v18, v140, v142, v144
    v_max3_f32 v16, v16, v17, v18
    v_mul_f32 v18, s66, v16
    v_fma_f32 v128, v128, s66, -v18
    v_fma_f32 v130, v130, s66, -v18
    v_fma_f32 v132, v132, s66, -v18
    v_fma_f32 v134, v134, s66, -v18
    v_fma_f32 v136, v136, s66, -v18
    v_fma_f32 v138, v138, s66, -v18
    v_fma_f32 v140, v140, s66, -v18
    v_fma_f32 v142, v142, s66, -v18
    v_fma_f32 v144, v144, s66, -v18
    v_exp_f32 v128, v128
    v_exp_f32 v130, v130
    v_exp_f32 v132, v132
    v_exp_f32 v134, v134
    v_exp_f32 v136, v136
    v_exp_f32 v138, v138
    v_exp_f32 v140, v140
    v_exp_f32 v142, v142
    v_exp_f32 v144, v144
    s_barrier
    ds_read_b128 v[72:75], v13 offset:7168
    ds_read_b128 v[76:79], v13 offset:8192
    ds_read_b128 v[80:83], v13 offset:9216
    ds_read_b128 v[84:87], v13 offset:10240
    ds_read_b128 v[88:91], v13 offset:11264
    ds_read_b128 v[92:95], v13 offset:12288
    ds_read_b128 v[96:99], v13 offset:13312
    ds_read_b128 v[100:103], v13 offset:14336
    ds_read_b128 v[104:107], v13 offset:15360
    v_mul_f32 v17, v128, v129
    v_fmac_f32 v17, v130, v131
    v_fmac_f32 v17, v132, v133
    v_fmac_f32 v17, v134, v135
    v_fmac_f32 v17, v136, v137
    v_fmac_f32 v17, v138, v139
    v_fmac_f32 v17, v140, v141
    v_fmac_f32 v17, v142, v143
    v_fmac_f32 v17, v144, v145
    v_mov_b32 v18, 0
    v_mov_b32 v19, 0
    v_bfi_b32 v28, v3, s48, v16
    v_bfi_b32 v29, v3, s49, v17
    v_bfi_b32 v30, v3, s50, v18
    v_bfi_b32 v31, v3, s51, v19
    s_mov_b32 exec_lo, 0xff
    s_mov_b32 exec_hi, 0xff
    s_add_u32 s69, s65, 524288
    buffer_store_dwordx4 v[28:31], v14, s[44:47], s69 offen
    buffer_store_dwordx4 v[28:31], v14, s[44:47], s65 offen sc1
    s_mov_b64 exec, -1
    s_waitcnt lgkmcnt(8)
    v_pk_mul_f32 v[20:21], v[72:73], v[128:129] op_sel_hi:[1,0]
    v_pk_mul_f32 v[22:23], v[74:75], v[128:129] op_sel_hi:[1,0]
    s_waitcnt lgkmcnt(7)
    v_pk_fma_f32 v[20:21], v[76:77], v[130:131], v[20:21] op_sel_hi:[1,0,1]
    v_pk_fma_f32 v[22:23], v[78:79], v[130:131], v[22:23] op_sel_hi:[1,0,1]
    s_waitcnt lgkmcnt(6)
    v_pk_fma_f32 v[20:21], v[80:81], v[132:133], v[20:21] op_sel_hi:[1,0,1]
    v_pk_fma_f32 v[22:23], v[82:83], v[132:133], v[22:23] op_sel_hi:[1,0,1]
    s_waitcnt lgkmcnt(5)
    v_pk_fma_f32 v[20:21], v[84:85], v[134:135], v[20:21] op_sel_hi:[1,0,1]
    v_pk_fma_f32 v[22:23], v[86:87], v[134:135], v[22:23] op_sel_hi:[1,0,1]
    s_waitcnt lgkmcnt(4)
    v_pk_fma_f32 v[20:21], v[88:89], v[136:137], v[20:21] op_sel_hi:[1,0,1]
    v_pk_fma_f32 v[22:23], v[90:91], v[136:137], v[22:23] op_sel_hi:[1,0,1]
    s_waitcnt lgkmcnt(3)
    v_pk_fma_f32 v[20:21], v[92:93], v[138:139], v[20:21] op_sel_hi:[1,0,1]
    v_pk_fma_f32 v[22:23], v[94:95], v[138:139], v[22:23] op_sel_hi:[1,0,1]
    s_waitcnt lgkmcnt(2)
    v_pk_fma_f32 v[20:21], v[96:97], v[140:141], v[20:21] op_sel_hi:[1,0,1]
    v_pk_fma_f32 v[22:23], v[98:99], v[140:141], v[22:23] op_sel_hi:[1,0,1]
    s_waitcnt lgkmcnt(1)
    v_pk_fma_f32 v[20:21], v[100:101], v[142:143], v[20:21] op_sel_hi:[1,0,1]
    v_pk_fma_f32 v[22:23], v[102:103], v[142:143], v[22:23] op_sel_hi:[1,0,1]
    s_waitcnt lgkmcnt(0)
    v_pk_fma_f32 v[20:21], v[104:105], v[144:145], v[20:21] op_sel_hi:[1,0,1]
    v_pk_fma_f32 v[22:23], v[106:107], v[144:145], v[22:23] op_sel_hi:[1,0,1]
    v_bfi_b32 v24, v3, s48, v20
    v_bfi_b32 v25, v3, s49, v21
    v_bfi_b32 v26, v3, s50, v22
    v_bfi_b32 v27, v3, s51, v23
    s_add_u32 s69, s62, 524288
    buffer_store_dwordx4 v[24:27], v10, s[44:47], s69 offen
    buffer_store_dwordx4 v[24:27], v10, s[44:47], s62 offen sc1
    ds_write_b32 v38, v39 offset:5640
L_GATHO:
    s_mov_b32 s59, 0
    buffer_load_dwordx4 v[52:55], v32, s[44:47], 0 offen sc1
    buffer_load_dwordx4 v[56:59], v33, s[44:47], 0 offen sc1
    buffer_load_dwordx4 v[60:63], v34, s[44:47], 0 offen sc1
    buffer_load_dwordx4 v[64:67], v35, s[44:47], 0 offen sc1
    buffer_load_dwordx4 v[68:71], v36, s[44:47], 0 offen sc1
    s_sleep 2
L_o_poll:
    buffer_load_dwordx4 v[108:111], v32, s[44:47], 0 offen sc1
    buffer_load_dwordx4 v[112:115], v33, s[44:47], 0 offen sc1
    buffer_load_dwordx4 v[116:119], v34, s[44:47], 0 offen sc1
    buffer_load_dwordx4 v[120:123], v35, s[44:47], 0 offen sc1
    buffer_load_dwordx4 v[124:127], v36, s[44:47], 0 offen sc1
    s_waitcnt vmcnt(9)
    v_xor_b32 v148, s48, v52
    v_xor_b32 v149, s49, v53
    v_xor_b32 v150, s50, v54
    v_xor_b32 v151, s51, v55
    v_or_b32 v11, v148, v149
    v_or3_b32 v11, v11, v150, v151
    s_waitcnt vmcnt(8)
    v_xor_b32 v152, s48, v56
    v_xor_b32 v153, s49, v57
    v_xor_b32 v154, s50, v58
    v_xor_b32 v155, s51, v59
    v_or3_b32 v11, v11, v152, v153
    v_or3_b32 v11, v11, v154, v155
    s_waitcnt vmcnt(7)
    v_xor_b32 v156, s48, v60
    v_xor_b32 v157, s49, v61
    v_xor_b32 v158, s50, v62
    v_xor_b32 v159, s51, v63
    v_or3_b32 v11, v11, v156, v157
    v_or3_b32 v11, v11, v158, v159
    s_waitcnt vmcnt(6)
    v_xor_b32 v160, s48, v64
    v_xor_b32 v161, s49, v65
    v_xor_b32 v162, s50, v66
    v_xor_b32 v163, s51, v67
    v_or3_b32 v11, v11, v160, v161
    v_or3_b32 v11, v11, v162, v163
    s_waitcnt vmcnt(5)
    v_xor_b32 v164, s48, v68
    v_xor_b32 v165, s49, v69
    v_xor_b32 v166, s50, v70
    v_xor_b32 v167, s51, v71
    v_or3_b32 v11, v11, v164, v165
    v_or3_b32 v11, v11, v166, v167
    v_cmp_ne_u32_sdwa vcc, v11, 0 src0_sel:BYTE_0 src1_sel:DWORD
    s_cbranch_vccz L_o_done
    buffer_load_dwordx4 v[52:55], v32, s[44:47], 0 offen sc1
    buffer_load_dwordx4 v[56:59], v33, s[44:47], 0 offen sc1
    buffer_load_dwordx4 v[60:63], v34, s[44:47], 0 offen sc1
    buffer_load_dwordx4 v[64:67], v35, s[44:47], 0 offen sc1
    buffer_load_dwordx4 v[68:71], v36, s[44:47], 0 offen sc1
    s_waitcnt vmcnt(9)
    v_xor_b32 v148, s48, v108
    v_xor_b32 v149, s49, v109
    v_xor_b32 v150, s50, v110
    v_xor_b32 v151, s51, v111
    v_or_b32 v11, v148, v149
    v_or3_b32 v11, v11, v150, v151
    s_waitcnt vmcnt(8)
    v_xor_b32 v152, s48, v112
    v_xor_b32 v153, s49, v113
    v_xor_b32 v154, s50, v114
    v_xor_b32 v155, s51, v115
    v_or3_b32 v11, v11, v152, v153
    v_or3_b32 v11, v11, v154, v155
    s_waitcnt vmcnt(7)
    v_xor_b32 v156, s48, v116
    v_xor_b32 v157, s49, v117
    v_xor_b32 v158, s50, v118
    v_xor_b32 v159, s51, v119
    v_or3_b32 v11, v11, v156, v157
    v_or3_b32 v11, v11, v158, v159
    s_waitcnt vmcnt(6)
    v_xor_b32 v160, s48, v120
    v_xor_b32 v161, s49, v121
    v_xor_b32 v162, s50, v122
    v_xor_b32 v163, s51, v123
    v_or3_b32 v11, v11, v160, v161
    v_or3_b32 v11, v11, v162, v163
    s_waitcnt vmcnt(5)
    v_xor_b32 v164, s48, v124
    v_xor_b32 v165, s49, v125
    v_xor_b32 v166, s50, v126
    v_xor_b32 v167, s51, v127
    v_or3_b32 v11, v11, v164, v165
    v_or3_b32 v11, v11, v166, v167
    v_cmp_ne_u32_sdwa vcc, v11, 0 src0_sel:BYTE_0 src1_sel:DWORD
    s_cbranch_vccz L_o_done
    s_add_u32 s59, s59, 1
    s_cmp_lt_u32 s59, 64
    s_cbranch_scc1 L_o_poll
    v_xor_b32 v32, 524288, v32
    v_xor_b32 v33, 524288, v33
    v_xor_b32 v34, 524288, v34
    v_xor_b32 v35, 524288, v35
    v_xor_b32 v36, 524288, v36
    s_cmp_lt_u32 s59, 0x18000
    s_cbranch_scc1 L_o_poll
L_o_done:
    v_permlane32_swap_b32 v148, v40
    v_permlane32_swap_b32 v149, v41
    v_permlane32_swap_b32 v152, v42
    v_permlane32_swap_b32 v153, v43
    v_permlane32_swap_b32 v156, v44
    v_permlane32_swap_b32 v157, v45
    v_permlane32_swap_b32 v160, v46
    v_permlane32_swap_b32 v161, v47
    v_permlane32_swap_b32 v164, v48
    v_permlane32_swap_b32 v165, v49
    v_max3_f32 v16, v40, v42, v44
    v_max3_f32 v16, v16, v46, v48
    v_mul_f32 v16, s66, v16
    v_fma_f32 v40, v40, s66, -v16
    v_fma_f32 v42, v42, s66, -v16
    v_fma_f32 v44, v44, s66, -v16
    v_fma_f32 v46, v46, s66, -v16
    v_fma_f32 v48, v48, s66, -v16
    v_exp_f32 v40, v40
    v_exp_f32 v42, v42
    v_exp_f32 v44, v44
    v_exp_f32 v46, v46
    v_exp_f32 v48, v48
    v_mul_f32 v18, v40, v41
    v_fmac_f32 v18, v42, v43
    v_fmac_f32 v18, v44, v45
    v_fmac_f32 v18, v46, v47
    v_fmac_f32 v18, v48, v49
    v_rcp_f32 v18, v18
    v_pk_mul_f32 v[20:21], v[148:149], v[40:41] op_sel_hi:[1,0]
    v_pk_mul_f32 v[22:23], v[150:151], v[40:41] op_sel_hi:[1,0]
    v_pk_fma_f32 v[20:21], v[152:153], v[42:43], v[20:21] op_sel_hi:[1,0,1]
    v_pk_fma_f32 v[22:23], v[154:155], v[42:43], v[22:23] op_sel_hi:[1,0,1]
    v_pk_fma_f32 v[20:21], v[156:157], v[44:45], v[20:21] op_sel_hi:[1,0,1]
    v_pk_fma_f32 v[22:23], v[158:159], v[44:45], v[22:23] op_sel_hi:[1,0,1]
    v_pk_fma_f32 v[20:21], v[160:161], v[46:47], v[20:21] op_sel_hi:[1,0,1]
    v_pk_fma_f32 v[22:23], v[162:163], v[46:47], v[22:23] op_sel_hi:[1,0,1]
    v_pk_fma_f32 v[20:21], v[164:165], v[48:49], v[20:21] op_sel_hi:[1,0,1]
    v_pk_fma_f32 v[22:23], v[166:167], v[48:49], v[22:23] op_sel_hi:[1,0,1]
    v_pk_mul_f32 v[20:21], v[20:21], v[18:19] op_sel_hi:[1,0]
    v_pk_mul_f32 v[22:23], v[22:23], v[18:19] op_sel_hi:[1,0]
    v_cvt_pk_bf16_f32 v20, v20, v20
    v_cvt_pk_bf16_f32 v21, v21, v21
    v_cvt_pk_bf16_f32 v22, v22, v22
    v_cvt_pk_bf16_f32 v23, v23, v23
    s_mov_b32 exec_hi, 0
    ds_write_b128 v37, v[20:23] offset:6144
    s_mov_b64 exec, 1
    ds_write_b32 v38, v39 offset:5632
    s_mov_b64 exec, -1
L_W0END:
    s_endpgm
L_ATT:
    v_and_b32 v12, 1, v0
    v_lshlrev_b32 v12, 4, v12
    v_mov_b32 v13, 0xffff
    v_lshlrev_b32 v12, v12, v13
    v_bfe_u32 v13, v0, 1, 2
    v_cmp_eq_u32 vcc, 0, v13
    s_nop 1
    v_cndmask_b32 v4, 0, v12, vcc
    v_cmp_eq_u32 vcc, 1, v13
    s_nop 1
    v_cndmask_b32 v5, 0, v12, vcc
    v_cmp_eq_u32 vcc, 2, v13
    s_nop 1
    v_cndmask_b32 v6, 0, v12, vcc
    v_cmp_eq_u32 vcc, 3, v13
    s_nop 1
    v_cndmask_b32 v7, 0, v12, vcc
    s_mov_b32 s60, 0xffff0000
    s_load_dword s52, s[30:31], 0
    v_lshrrev_b32 v12, 3, v1
    v_mul_u32_u24 v13, 0x202, v12
    v_add_u32 v13, 0x100, v13
    v_lshl_or_b32 v13, v13, 16, v13
    v_mov_b32 v14, 0x0c0c0c0c
    v_bfi_b32 v4, v4, v13, v14
    v_bfi_b32 v5, v5, v13, v14
    v_bfi_b32 v6, v6, v13, v14
    v_bfi_b32 v7, v7, v13, v14
    v_lshlrev_b32 v13, 8, v12
    v_and_b32 v14, 1, v0
    v_lshl_add_u32 v13, v14, 6, v13
    v_lshl_add_u32 v13, v2, 4, v13
    v_bfe_u32 v14, v0, 1, 2
    v_mov_b32 v15, 768
    v_cmp_eq_u32 vcc, 0, v14
    s_nop 1
    v_cndmask_b32 v100, v15, v13, vcc
    v_cmp_eq_u32 vcc, 1, v14
    s_nop 1
    v_cndmask_b32 v101, v15, v13, vcc
    v_cmp_eq_u32 vcc, 2, v14
    s_nop 1
    v_cndmask_b32 v102, v15, v13, vcc
    v_mov_b32 v13, s67
    v_cndmask_b32 v92, 0, v13, vcc
    v_mov_b32 v13, 0xf149f2ca
    v_cmp_eq_u32 vcc, 3, v14
    s_nop 1
    v_cndmask_b32 v92, v92, v13, vcc
    v_lshlrev_b32 v12, 7, v12
    s_lshl_b32 s62, s57, 3
    v_add_u32 v14, s62, v12
    v_mov_b32 v93, v92
    v_mov_b32 v94, v92
    v_mov_b32 v95, v92
    s_lshl_b32 s62, s57, 10
    v_lshlrev_b32 v15, 4, v0
    v_add_u32 v15, s62, v15
    s_mov_b32 s63, 0x3db504f3
    s_mov_b32 s64, 0x3fb8aa3b
    s_lshl_b32 s56, s4, 2
    s_add_u32 s56, s56, s53
    s_lshl_b32 s56, s56, 1
    v_lshrrev_b32 v3, 3, v0
    v_mul_u32_u24 v124, 9216, v3
    v_and_b32 v3, 7, v0
    v_lshl_add_u32 v124, v3, 4, v124
    s_mov_b32 s40, s16
    s_and_b32 s41, s17, 0xffff
    s_mov_b32 s42, 4718592
    s_mov_b32 s43, 0x20000
    s_lshr_b32 s65, s57, 1
    s_lshl_b32 s66, s65, 1
    s_sub_u32 s66, 7, s66
    s_lshr_b32 s67, s55, 1
    s_and_b32 s69, s55, 1
    s_lshl_b32 s68, s69, 2
    s_cmp_eq_u32 s55, 4
    s_cselect_b32 s67, s65, s67
    s_cselect_b32 s68, s66, s68
    s_cselect_b32 s18, s65, 0
    s_sub_u32 s66, 4, s69
    s_lshl_b32 s18, s18, 9
    s_mov_b32 s19, 0
    s_cmp_lt_u32 s57, s66
    s_cselect_b64 vcc, -1, 0
    s_cbranch_scc1 L_JWO
    s_lshr_b32 s65, s55, 1
    s_lshl_b32 s65, s65, 2
    s_add_u32 s65, s65, s53
    s_cmp_eq_u32 s5, 28
    s_cselect_b32 s66, 8, s5
    s_cmp_eq_u32 s57, 4
    s_cselect_b32 s65, s66, s65
    s_cmp_ge_u32 s57, 5
    s_cbranch_scc1 L_JD
    s_cmp_eq_u32 s4, 3
    s_cselect_b32 s66, 18, 9
    s_cmp_ge_u32 s65, s66
    s_cbranch_scc1 L_JD
    s_cmp_ge_u32 s65, 9
    s_cselect_b32 s57, 7, 6
    s_cselect_b32 s66, 9, 0
    s_sub_u32 s65, s65, s66
    s_mul_i32 s56, s4, 9
    s_add_u32 s56, s56, s65
    s_add_u32 s58, s56, 64
    s_mov_b32 s19, 1
    s_mov_b64 vcc, -1
    s_mov_b32 s40, s24
    s_and_b32 s41, s25, 0xffff
    s_mov_b32 s42, 5308416
    s_mov_b32 s43, 0x20000
    s_branch L_JD
L_JWO:
    s_add_u32 s57, s57, s68
    s_add_u32 s56, s56, s67
    s_mov_b32 s58, s56
L_JD:
    s_mul_i32 s61, s56, 73728
    s_lshl_b32 s62, s57, 7
    s_add_u32 s61, s61, s62
    s_mov_b32 s68, 0xaaaaaaaa
    s_mov_b32 s69, 0xaaaaaaaa
    s_waitcnt lgkmcnt(0)
    s_waitcnt vmcnt(3)
    buffer_load_dwordx4 v[32:35], v9, s[32:35], 0 offen offset:0 nt
    s_waitcnt vmcnt(3)
    buffer_load_dwordx4 v[36:39], v9, s[32:35], 0 offen offset:128 nt
    s_waitcnt vmcnt(3)
    buffer_load_dwordx4 v[40:43], v10, s[36:39], 0 offen offset:0 nt
    s_waitcnt vmcnt(3)
    buffer_load_dwordx4 v[44:47], v10, s[36:39], 0 offen offset:256 nt
    s_waitcnt vmcnt(3)
    buffer_load_dwordx4 v[48:51], v10, s[36:39], 0 offen offset:2048 nt
    s_waitcnt vmcnt(3)
    buffer_load_dwordx4 v[52:55], v10, s[36:39], 0 offen offset:2304 nt
    s_waitcnt vmcnt(3)
    buffer_load_dwordx4 v[56:59], v11, s[36:39], 0 offen offset:0 nt
    s_waitcnt vmcnt(3)
    buffer_load_dwordx4 v[60:63], v11, s[36:39], 0 offen offset:256 nt
    s_barrier
    ds_read_b128 v[64:67], v100 offset:4608
    ds_read_b128 v[68:71], v100 offset:4736
    ds_read_b128 v[72:75], v101 offset:4608
    ds_read_b128 v[76:79], v101 offset:4736
    ds_read_b128 v[80:83], v102 offset:4608
    ds_read_b128 v[84:87], v102 offset:4736
    s_waitcnt vmcnt(6)
    s_cbranch_vccz L_WOS1
    buffer_load_dwordx4 v[132:135], v124, s[40:43], s61 offen offset:0 nt
    buffer_load_dwordx4 v[136:139], v124, s[40:43], s61 offen offset:1152 nt
    buffer_load_dwordx4 v[140:143], v124, s[40:43], s61 offen offset:2304 nt
L_WOS1:
    s_waitcnt lgkmcnt(5)
    v_mfma_f32_16x16x32_bf16 v[88:91], v[16:19], v[64:67], v[92:95]
    s_waitcnt lgkmcnt(4)
    v_mfma_f32_16x16x32_bf16 v[88:91], v[20:23], v[68:71], v[88:91]
    s_waitcnt lgkmcnt(3)
    v_mfma_f32_16x16x32_bf16 v[88:91], v[24:27], v[72:75], v[88:91]
    s_waitcnt lgkmcnt(2)
    v_mfma_f32_16x16x32_bf16 v[88:91], v[28:31], v[76:79], v[88:91]
    s_waitcnt lgkmcnt(1)
    v_mfma_f32_16x16x32_bf16 v[88:91], v[32:35], v[80:83], v[88:91]
    s_waitcnt lgkmcnt(0)
    v_mfma_f32_16x16x32_bf16 v[88:91], v[36:39], v[84:87], v[88:91]
    s_nop 7
    v_cndmask_b32 v105, v90, v89, s[68:69]
    v_cndmask_b32 v104, v88, v91, s[68:69]
    s_nop 0
    v_add_f32 v104, v105, v104 quad_perm:[1,0,3,2] row_mask:0xf bank_mask:0xf
    v_cvt_pk_bf16_f32 v104, v104, v104
    v_and_b32 v104, s60, v104
    v_mul_f32 v104, s63, v104
    v_cvt_pk_bf16_f32 v104, v104, v104
    v_and_b32 v104, s60, v104
    s_nop 1
    v_max_f32 v106, v104, v104 quad_perm:[1,0,3,2] row_mask:0xf bank_mask:0xf
    s_nop 1
    v_max_f32 v106, v106, v106 quad_perm:[2,3,0,1] row_mask:0xf bank_mask:0xf
    s_nop 1
    v_max_f32 v106, v106, v106 row_half_mirror row_mask:0xf bank_mask:0xf
    v_mov_b32 v105, v106
    s_nop 1
    v_permlane16_swap_b32 v106, v105
    v_max_f32 v106, v106, v105
    v_mov_b32 v105, v106
    s_nop 1
    v_permlane32_swap_b32 v106, v105
    v_max_f32 v106, v106, v105
    v_sub_f32 v104, v104, v106
    v_mul_f32 v104, s64, v104
    v_exp_f32 v104, v104
    s_cbranch_vccz L_WOS2
    buffer_load_dwordx4 v[144:147], v124, s[40:43], s61 offen offset:3456 nt
    s_add_u32 s61, s61, 4608
    buffer_load_dwordx4 v[148:151], v124, s[40:43], s61 offen offset:0 nt
    buffer_load_dwordx4 v[152:155], v124, s[40:43], s61 offen offset:1152 nt
L_WOS2:
    s_nop 0
    v_mov_b32 v105, v104 row_ror:8 row_mask:0xf bank_mask:0xf
    v_add_f32 v107, v104, v104 quad_perm:[1,0,3,2] row_mask:0xf bank_mask:0xf
    v_cvt_pk_bf16_f32 v108, v104, v105
    s_nop 0
    v_add_f32 v107, v107, v107 quad_perm:[2,3,0,1] row_mask:0xf bank_mask:0xf
    v_mov_b32 v110, v108 row_newbcast:0 row_mask:0xf bank_mask:0xf
    v_mov_b32 v111, v108 row_newbcast:1 row_mask:0xf bank_mask:0xf
    v_add_f32 v107, v107, v107 row_half_mirror row_mask:0xf bank_mask:0xf
    v_mov_b32 v112, v108 row_newbcast:2 row_mask:0xf bank_mask:0xf
    v_mov_b32 v113, v108 row_newbcast:3 row_mask:0xf bank_mask:0xf
    v_mov_b32 v105, v107
    v_mov_b32 v114, v108 row_newbcast:4 row_mask:0xf bank_mask:0xf
    v_mov_b32 v115, v108 row_newbcast:5 row_mask:0xf bank_mask:0xf
    v_permlane16_swap_b32 v107, v105
    v_perm_b32 v16, v110, v110, v4
    v_perm_b32 v17, v110, v110, v5
    v_add_f32 v107, v107, v105
    v_perm_b32 v18, v110, v110, v6
    v_perm_b32 v19, v110, v110, v7
    v_mov_b32 v105, v107
    v_perm_b32 v20, v111, v111, v4
    v_perm_b32 v21, v111, v111, v5
    v_permlane32_swap_b32 v107, v105
    v_perm_b32 v22, v111, v111, v6
    v_perm_b32 v23, v111, v111, v7
    v_add_f32 v107, v107, v105
    s_mov_b64 exec, 0x101
    ds_write_b64 v14, v[106:107] offset:5120
    s_mov_b64 exec, -1
    s_cbranch_vccnz L_PVW0
    s_waitcnt vmcnt(5)
L_PVW0:
    s_waitcnt vmcnt(11)
    v_mfma_f32_16x16x32_bf16 v[96:99], v[16:19], v[40:43], 0
    v_perm_b32 v24, v112, v112, v4
    v_perm_b32 v25, v112, v112, v5
    v_perm_b32 v26, v112, v112, v6
    v_perm_b32 v27, v112, v112, v7
    s_cbranch_vccnz L_PVW1
    s_waitcnt vmcnt(4)
L_PVW1:
    s_waitcnt vmcnt(10)
    v_mfma_f32_16x16x32_bf16 v[96:99], v[20:23], v[44:47], v[96:99]
    v_perm_b32 v28, v113, v113, v4
    v_perm_b32 v29, v113, v113, v5
    v_perm_b32 v30, v113, v113, v6
    v_perm_b32 v31, v113, v113, v7
    s_cbranch_vccnz L_PVW2
    s_waitcnt vmcnt(3)
L_PVW2:
    s_waitcnt vmcnt(9)
    v_mfma_f32_16x16x32_bf16 v[96:99], v[24:27], v[48:51], v[96:99]
    v_perm_b32 v32, v114, v114, v4
    v_perm_b32 v33, v114, v114, v5
    v_perm_b32 v34, v114, v114, v6
    v_perm_b32 v35, v114, v114, v7
    s_cbranch_vccnz L_PVW3
    s_waitcnt vmcnt(2)
L_PVW3:
    s_waitcnt vmcnt(8)
    v_mfma_f32_16x16x32_bf16 v[96:99], v[28:31], v[52:55], v[96:99]
    v_perm_b32 v36, v115, v115, v4
    v_perm_b32 v37, v115, v115, v5
    v_perm_b32 v38, v115, v115, v6
    v_perm_b32 v39, v115, v115, v7
    s_cbranch_vccnz L_PVW4
    s_waitcnt vmcnt(1)
L_PVW4:
    s_waitcnt vmcnt(7)
    v_mfma_f32_16x16x32_bf16 v[96:99], v[32:35], v[56:59], v[96:99]
    s_cbranch_vccnz L_PVW5
    s_waitcnt vmcnt(0)
L_PVW5:
    s_waitcnt vmcnt(6)
    v_mfma_f32_16x16x32_bf16 v[96:99], v[36:39], v[60:63], v[96:99]
    s_nop 7
    ds_write_b128 v15, v[96:99] offset:7168
    s_cbranch_vccz L_WOS3
    buffer_load_dwordx4 v[156:159], v124, s[40:43], s61 offen offset:2304 nt
    buffer_load_dwordx4 v[160:163], v124, s[40:43], s61 offen offset:3456 nt
L_WOS3:
    s_waitcnt lgkmcnt(0)
    s_barrier
    s_cbranch_vccnz L_TAIL
L_ANOJOB:
L_NOJOB:
    s_endpgm
L_FFN2:
    s_load_dword s52, s[30:31], 0
    v_lshrrev_b32 v8, 3, v0
    v_mul_u32_u24 v124, 9216, v8
    v_and_b32 v8, 7, v0
    v_lshl_add_u32 v124, v8, 4, v124
    v_and_b32 v16, 1, v0
    v_lshlrev_b32 v16, 4, v16
    v_mov_b32 v17, 0xffff
    v_lshlrev_b32 v16, v16, v17
    v_bfe_u32 v17, v0, 1, 2
    v_cmp_eq_u32 vcc, 0, v17
    s_nop 1
    v_cndmask_b32 v20, 0, v16, vcc
    v_cmp_eq_u32 vcc, 1, v17
    s_nop 1
    v_cndmask_b32 v21, 0, v16, vcc
    v_cmp_eq_u32 vcc, 2, v17
    s_nop 1
    v_cndmask_b32 v22, 0, v16, vcc
    v_cmp_eq_u32 vcc, 3, v17
    s_nop 1
    v_cndmask_b32 v23, 0, v16, vcc
    s_add_u32 s58, s56, 64
    s_mov_b32 s18, 0
    v_bfe_u32 v16, v0, 3, 1
    v_mul_u32_u24 v16, 2304, v16
    v_lshl_add_u32 v16, v2, 6, v16
    s_lshl_b32 s61, s57, 8
    v_add_u32 v16, s61, v16
    s_lshl_b32 s61, s57, 10
    v_lshlrev_b32 v17, 4, v0
    v_add_u32 v17, s61, v17
    s_cmp_eq_u32 s4, 3
    s_cselect_b32 s61, 6, 6
    s_cmp_lt_u32 s57, s61
    s_cselect_b64 vcc, -1, 0
    s_mov_b32 s19, 0
    s_mul_i32 s61, s56, 73728
    s_lshl_b32 s62, s57, 7
    s_add_u32 s61, s61, s62
    s_mov_b32 s32, s24
    s_and_b32 s33, s25, 0xffff
    s_mov_b32 s34, 5308416
    s_mov_b32 s35, 0x20000
    s_waitcnt vmcnt(2)
    global_load_dwordx4 v[44:47], v[14:15], off nt
    v_lshl_add_u64 v[14:15], v[14:15], 0, s[64:65]
    s_waitcnt vmcnt(2)
    global_load_dwordx4 v[48:51], v[14:15], off nt
    v_lshl_add_u64 v[14:15], v[14:15], 0, s[64:65]
    s_waitcnt vmcnt(2)
    global_load_dwordx4 v[52:55], v[14:15], off nt
    v_lshl_add_u64 v[14:15], v[14:15], 0, s[64:65]
    s_waitcnt vmcnt(2)
    global_load_dwordx4 v[56:59], v[14:15], off nt
    v_lshl_add_u64 v[14:15], v[14:15], 0, s[64:65]
    s_waitcnt vmcnt(2)
    global_load_dwordx4 v[60:63], v[14:15], off nt
    v_lshl_add_u64 v[14:15], v[14:15], 0, s[64:65]
    s_waitcnt vmcnt(2)
    global_load_dwordx4 v[64:67], v[14:15], off nt
    v_lshl_add_u64 v[14:15], v[14:15], 0, s[64:65]
    s_waitcnt vmcnt(2)
    global_load_dwordx4 v[68:71], v[14:15], off nt
    v_lshl_add_u64 v[14:15], v[14:15], 0, s[64:65]
    global_load_dwordx4 v[72:75], v[14:15], off nt
    v_lshl_add_u64 v[14:15], v[14:15], 0, s[64:65]
    global_load_dwordx4 v[76:79], v[14:15], off nt
    v_lshl_add_u64 v[14:15], v[14:15], 0, s[64:65]
    global_load_dwordx4 v[80:83], v[14:15], off nt
    v_lshl_add_u64 v[14:15], v[14:15], 0, s[64:65]
    global_load_dwordx4 v[84:87], v[14:15], off nt
    v_lshl_add_u64 v[14:15], v[14:15], 0, s[64:65]
    global_load_dwordx4 v[88:91], v[14:15], off nt
    v_lshl_add_u64 v[14:15], v[14:15], 0, s[64:65]
    global_load_dwordx4 v[92:95], v[14:15], off nt
    s_barrier
    ds_read_b128 v[96:99], v16 offset:0
    ds_read_b128 v[100:103], v16 offset:16
    ds_read_b128 v[104:107], v16 offset:32
    ds_read_b128 v[108:111], v16 offset:48
    s_waitcnt lgkmcnt(0)
    s_cbranch_vccz L_FN0
    buffer_load_dwordx4 v[132:135], v124, s[32:35], s61 offen offset:0 nt
L_FN0:
    v_and_b32 v112, v20, v96
    v_and_b32 v113, v21, v96
    v_and_b32 v114, v22, v96
    v_and_b32 v115, v23, v96
    v_and_b32 v116, v20, v97
    v_and_b32 v117, v21, v97
    v_and_b32 v118, v22, v97
    v_and_b32 v119, v23, v97
    s_cbranch_vccnz L_FW0
    s_waitcnt vmcnt(14)
L_FW0:
    s_waitcnt vmcnt(15)
    v_mfma_f32_16x16x32_bf16 v[120:123], v[112:115], v[32:35], 0
    v_mfma_f32_16x16x32_bf16 v[120:123], v[116:119], v[36:39], v[120:123]
    s_cbranch_vccz L_FN1
    buffer_load_dwordx4 v[136:139], v124, s[32:35], s61 offen offset:1152 nt
L_FN1:
    v_and_b32 v112, v20, v98
    v_and_b32 v113, v21, v98
    v_and_b32 v114, v22, v98
    v_and_b32 v115, v23, v98
    v_and_b32 v116, v20, v99
    v_and_b32 v117, v21, v99
    v_and_b32 v118, v22, v99
    v_and_b32 v119, v23, v99
    s_cbranch_vccnz L_FW1
    s_waitcnt vmcnt(12)
L_FW1:
    s_waitcnt vmcnt(14)
    v_mfma_f32_16x16x32_bf16 v[120:123], v[112:115], v[40:43], v[120:123]
    v_mfma_f32_16x16x32_bf16 v[120:123], v[116:119], v[44:47], v[120:123]
    s_cbranch_vccz L_FN2
    buffer_load_dwordx4 v[140:143], v124, s[32:35], s61 offen offset:2304 nt
L_FN2:
    v_and_b32 v112, v20, v100
    v_and_b32 v113, v21, v100
    v_and_b32 v114, v22, v100
    v_and_b32 v115, v23, v100
    v_and_b32 v116, v20, v101
    v_and_b32 v117, v21, v101
    v_and_b32 v118, v22, v101
    v_and_b32 v119, v23, v101
    s_cbranch_vccnz L_FW2
    s_waitcnt vmcnt(10)
L_FW2:
    s_waitcnt vmcnt(13)
    v_mfma_f32_16x16x32_bf16 v[120:123], v[112:115], v[48:51], v[120:123]
    v_mfma_f32_16x16x32_bf16 v[120:123], v[116:119], v[52:55], v[120:123]
    s_cbranch_vccz L_FN3
    buffer_load_dwordx4 v[144:147], v124, s[32:35], s61 offen offset:3456 nt
L_FN3:
    v_and_b32 v112, v20, v102
    v_and_b32 v113, v21, v102
    v_and_b32 v114, v22, v102
    v_and_b32 v115, v23, v102
    v_and_b32 v116, v20, v103
    v_and_b32 v117, v21, v103
    v_and_b32 v118, v22, v103
    v_and_b32 v119, v23, v103
    s_cbranch_vccnz L_FW3
    s_waitcnt vmcnt(8)
L_FW3:
    s_waitcnt vmcnt(12)
    v_mfma_f32_16x16x32_bf16 v[120:123], v[112:115], v[56:59], v[120:123]
    v_mfma_f32_16x16x32_bf16 v[120:123], v[116:119], v[60:63], v[120:123]
    s_cbranch_vccz L_FN4
    s_add_u32 s61, s61, 4608
    buffer_load_dwordx4 v[148:151], v124, s[32:35], s61 offen offset:0 nt
L_FN4:
    v_and_b32 v112, v20, v104
    v_and_b32 v113, v21, v104
    v_and_b32 v114, v22, v104
    v_and_b32 v115, v23, v104
    v_and_b32 v116, v20, v105
    v_and_b32 v117, v21, v105
    v_and_b32 v118, v22, v105
    v_and_b32 v119, v23, v105
    s_cbranch_vccnz L_FW4
    s_waitcnt vmcnt(6)
L_FW4:
    s_waitcnt vmcnt(11)
    v_mfma_f32_16x16x32_bf16 v[120:123], v[112:115], v[64:67], v[120:123]
    v_mfma_f32_16x16x32_bf16 v[120:123], v[116:119], v[68:71], v[120:123]
    s_cbranch_vccz L_FN5
    buffer_load_dwordx4 v[152:155], v124, s[32:35], s61 offen offset:1152 nt
L_FN5:
    v_and_b32 v112, v20, v106
    v_and_b32 v113, v21, v106
    v_and_b32 v114, v22, v106
    v_and_b32 v115, v23, v106
    v_and_b32 v116, v20, v107
    v_and_b32 v117, v21, v107
    v_and_b32 v118, v22, v107
    v_and_b32 v119, v23, v107
    s_cbranch_vccnz L_FW5
    s_waitcnt vmcnt(4)
L_FW5:
    s_waitcnt vmcnt(10)
    v_mfma_f32_16x16x32_bf16 v[120:123], v[112:115], v[72:75], v[120:123]
    v_mfma_f32_16x16x32_bf16 v[120:123], v[116:119], v[76:79], v[120:123]
    s_cbranch_vccz L_FN6
    buffer_load_dwordx4 v[156:159], v124, s[32:35], s61 offen offset:2304 nt
L_FN6:
    v_and_b32 v112, v20, v108
    v_and_b32 v113, v21, v108
    v_and_b32 v114, v22, v108
    v_and_b32 v115, v23, v108
    v_and_b32 v116, v20, v109
    v_and_b32 v117, v21, v109
    v_and_b32 v118, v22, v109
    v_and_b32 v119, v23, v109
    s_cbranch_vccnz L_FW6
    s_waitcnt vmcnt(2)
L_FW6:
    s_waitcnt vmcnt(9)
    v_mfma_f32_16x16x32_bf16 v[120:123], v[112:115], v[80:83], v[120:123]
    v_mfma_f32_16x16x32_bf16 v[120:123], v[116:119], v[84:87], v[120:123]
    s_cbranch_vccz L_FN7
    buffer_load_dwordx4 v[160:163], v124, s[32:35], s61 offen offset:3456 nt
L_FN7:
    v_and_b32 v112, v20, v110
    v_and_b32 v113, v21, v110
    v_and_b32 v114, v22, v110
    v_and_b32 v115, v23, v110
    v_and_b32 v116, v20, v111
    v_and_b32 v117, v21, v111
    v_and_b32 v118, v22, v111
    v_and_b32 v119, v23, v111
    s_cbranch_vccnz L_FW7
    s_waitcnt vmcnt(0)
L_FW7:
    s_waitcnt vmcnt(8)
    v_mfma_f32_16x16x32_bf16 v[120:123], v[112:115], v[88:91], v[120:123]
    v_mfma_f32_16x16x32_bf16 v[120:123], v[116:119], v[92:95], v[120:123]
    s_nop 7
    ds_write_b128 v17, v[120:123] offset:7168
    s_waitcnt lgkmcnt(0)
    s_barrier
    s_cbranch_vccz L_NOJOB
    s_mov_b32 s32, s8
    s_and_b32 s33, s9, 0xffff
    s_mov_b32 s34, 2304
    s_mov_b32 s35, 0x20000
    s_mov_b32 s36, s26
    s_and_b32 s37, s27, 0xffff
    s_mov_b32 s38, 2304
    s_mov_b32 s39, 0x20000
    s_lshr_b32 s62, s56, 3
    s_lshl_b32 s65, s62, 7
    s_and_b32 s63, s56, 3
    s_lshl_b32 s66, s63, 5
    s_add_u32 s65, s65, s66
    s_bfe_u32 s64, s56, 0x10002
    s_mul_i32 s66, s64, 1152
    s_add_u32 s65, s65, s66
    v_and_b32 v69, 3, v0
    v_lshlrev_b32 v65, 3, v69
    v_lshl_add_u32 v65, v2, 1, v65
    v_add_u32 v65, s65, v65
    buffer_load_ushort v66, v65, s[32:35], 0 offen
    s_lshl_b32 s62, s62, 2
    s_add_u32 s62, s62, s63
    s_mul_i32 s62, s62, 17408
    s_lshl_b32 s64, s64, 6
    s_add_u32 s62, s62, s64
    s_add_u32 s62, s62, 1048576
    s_lshl_b32 s64, s57, 12
    s_mul_i32 s65, s57, 3072
    s_add_u32 s65, s65, 2048
    s_cmp_lt_u32 s57, 2
    s_cselect_b32 s64, s64, s65
    s_cselect_b32 s20, -1, 0
    s_add_u32 s62, s62, s64
    v_lshrrev_b32 v64, 2, v0
    v_lshlrev_b32 v64, 7, v64
    v_lshl_add_u32 v64, v69, 4, v64
    v_add_u32 v64, s62, v64
    s_lshl_b32 s64, s57, 10
    v_lshlrev_b32 v67, 4, v0
    v_add_u32 v68, s64, v67
    s_mov_b32 s60, 0xffff0000
    v_mov_b32 v76, 0
    v_mov_b32 v77, 0
    v_mov_b32 v78, 0
    v_mov_b32 v79, 0
L_TAIL:
    v_and_b32 v12, 1, v0
    v_lshlrev_b32 v12, 4, v12
    v_mov_b32 v13, 0xffff
    v_lshlrev_b32 v12, v12, v13
    v_bfe_u32 v13, v0, 1, 1
    v_cmp_eq_u32 vcc, 0, v13
    s_nop 1
    v_cndmask_b32 v4, 0, v12, vcc
    v_cmp_eq_u32 vcc, 1, v13
    s_nop 1
    v_cndmask_b32 v5, 0, v12, vcc
    v_bfe_u32 v12, v0, 2, 1
    v_lshlrev_b32 v12, 8, v12
    v_lshrrev_b32 v10, 3, v0
    v_lshl_add_u32 v9, v10, 5, v12
    s_add_u32 s48, s52, 1
    s_and_b32 s48, s48, 0xff
    s_add_u32 s49, s52, 72
    s_and_b32 s49, s49, 0xff
    s_add_u32 s50, s52, 142
    s_and_b32 s50, s50, 0xff
    s_add_u32 s51, s52, 215
    s_and_b32 s51, s51, 0xff
    s_mov_b32 s44, s30
    s_and_b32 s45, s31, 0xffff
    s_mov_b32 s46, 4194304
    s_mov_b32 s47, 0x20000
    v_bfe_u32 v13, v0, 1, 2
    v_mul_u32_u24 v12, 17408, v13
    v_and_b32 v13, 1, v2
    v_lshl_add_u32 v12, v13, 6, v12
    v_and_b32 v13, 1, v0
    v_lshl_add_u32 v12, v13, 5, v12
    v_lshrrev_b32 v13, 5, v0
    v_lshl_add_u32 v12, v13, 4, v12
    s_mul_i32 s61, s57, 69632
    s_lshl_b32 s62, s58, 7
    s_add_u32 s61, s61, s62
    s_add_u32 s61, s61, 1048576
    v_mov_b32 v15, 0xff
    v_mov_b32 v13, 0x03020302
    v_mov_b32 v14, 0x0c0c0c0c
    v_bfi_b32 v4, v4, v13, v14
    v_bfi_b32 v5, v5, v13, v14
    s_cmp_lt_u32 s5, 9
    s_cbranch_scc1 L_TNS
    s_waitcnt vmcnt(6)
    v_swap_b32 v134, v136
    v_swap_b32 v135, v137
    s_waitcnt vmcnt(4)
    v_swap_b32 v142, v144
    v_swap_b32 v143, v145
    s_waitcnt vmcnt(2)
    v_swap_b32 v150, v152
    v_swap_b32 v151, v153
    s_waitcnt vmcnt(0)
    v_swap_b32 v158, v160
    v_swap_b32 v159, v161
L_TNS:
    s_cmp_eq_u32 s19, 1
    s_cbranch_scc1 L_TAILH
    v_add_u32 v9, s18, v9
    s_lshr_b32 s62, s18, 7
    v_mov_b32 v10, s62
    s_mov_b32 s59, 0
L_AVP:
    ds_read_b32 v11, v10 offset:5632
    ds_read_b128 v[96:99], v9 offset:6144
    ds_read_b128 v[100:103], v9 offset:6160
    s_add_u32 s59, s59, 1
    s_cmp_lt_u32 s59, 0x200000
    s_waitcnt lgkmcnt(0)
    s_cbranch_scc0 L_AVD
    v_cmp_eq_u32 vcc, 0, v11
    s_cbranch_vccnz L_AVP
L_AVD:
    s_cmp_lt_u32 s5, 9
    s_cbranch_scc1 L_TAILF
L_TAILM:
    v_perm_b32 v16, v96, v96, v4
    v_perm_b32 v17, v96, v96, v5
    v_perm_b32 v18, v97, v97, v4
    v_perm_b32 v19, v97, v97, v5
    v_perm_b32 v20, v98, v98, v4
    v_perm_b32 v21, v98, v98, v5
    v_perm_b32 v22, v99, v99, v4
    v_perm_b32 v23, v99, v99, v5
    v_mfma_f32_16x16x32_bf16 v[104:107], v[16:19], v[132:135], 0
    v_mfma_f32_16x16x32_bf16 v[108:111], v[16:19], v[136:139], 0
    v_perm_b32 v24, v100, v100, v4
    v_perm_b32 v25, v100, v100, v5
    v_perm_b32 v26, v101, v101, v4
    v_perm_b32 v27, v101, v101, v5
    v_mfma_f32_16x16x32_bf16 v[104:107], v[20:23], v[140:143], v[104:107]
    v_mfma_f32_16x16x32_bf16 v[108:111], v[20:23], v[144:147], v[108:111]
    v_perm_b32 v28, v102, v102, v4
    v_perm_b32 v29, v102, v102, v5
    v_perm_b32 v30, v103, v103, v4
    v_perm_b32 v31, v103, v103, v5
    v_mfma_f32_16x16x32_bf16 v[104:107], v[24:27], v[148:151], v[104:107]
    v_mfma_f32_16x16x32_bf16 v[108:111], v[24:27], v[152:155], v[108:111]
    v_mfma_f32_16x16x32_bf16 v[104:107], v[28:31], v[156:159], v[104:107]
    v_mfma_f32_16x16x32_bf16 v[108:111], v[28:31], v[160:163], v[108:111]
L_TAILE:
    s_nop 7
    v_permlane32_swap_b32 v104, v108
    v_permlane32_swap_b32 v105, v109
    v_permlane32_swap_b32 v106, v110
    v_permlane32_swap_b32 v107, v111
    v_add_f32 v104, v108, v104 row_ror:8 row_mask:0xf bank_mask:0xf
    v_add_f32 v105, v109, v105 row_ror:8 row_mask:0xf bank_mask:0xf
    v_add_f32 v106, v110, v106 row_ror:8 row_mask:0xf bank_mask:0xf
    v_add_f32 v107, v111, v107 row_ror:8 row_mask:0xf bank_mask:0xf
    v_bfi_b32 v104, v15, s48, v104
    v_bfi_b32 v105, v15, s49, v105
    v_bfi_b32 v106, v15, s50, v106
    v_bfi_b32 v107, v15, s51, v107
    s_cmp_lt_u32 s5, 29
    s_cbranch_scc1 L_NHB
    s_barrier
L_NHB:
    s_mov_b32 exec_lo, 0x00ff00ff
    s_mov_b32 exec_hi, 0x00ff00ff
    buffer_store_dwordx4 v[104:107], v12, s[44:47], s61 offen sc1
    s_mov_b64 exec, -1
    s_cmp_ge_u32 s5, 9
    s_cbranch_scc1 L_W0END
    s_barrier
    s_cmp_lt_u32 s57, 5
    s_cbranch_scc1 L_CONS
    s_endpgm
L_TAILH:
    s_lshl_b32 s62, s56, 9
    s_add_u32 s62, s62, 339968
    v_add_u32 v9, 524288, v9
    s_mov_b32 s59, 0
    buffer_load_dwordx4 v[112:115], v9, s[44:47], s62 offen offset:0 sc1
    buffer_load_dwordx4 v[116:119], v9, s[44:47], s62 offen offset:16 sc1
    s_sleep 2
L_h_poll:
    buffer_load_dwordx4 v[80:83], v9, s[44:47], s62 offen offset:0 sc1
    buffer_load_dwordx4 v[84:87], v9, s[44:47], s62 offen offset:16 sc1
    s_waitcnt vmcnt(3)
    v_xor_b32 v96, s48, v112
    v_xor_b32 v97, s49, v113
    v_xor_b32 v98, s50, v114
    v_xor_b32 v99, s51, v115
    v_or_b32 v11, v96, v97
    v_or3_b32 v11, v11, v98, v99
    s_waitcnt vmcnt(2)
    v_xor_b32 v100, s48, v116
    v_xor_b32 v101, s49, v117
    v_xor_b32 v102, s50, v118
    v_xor_b32 v103, s51, v119
    v_or3_b32 v11, v11, v100, v101
    v_or3_b32 v11, v11, v102, v103
    v_cmp_ne_u32_sdwa vcc, v11, 0 src0_sel:BYTE_0 src1_sel:DWORD
    s_cbranch_vccz L_h_done
    s_sleep 1
    buffer_load_dwordx4 v[112:115], v9, s[44:47], s62 offen offset:0 sc1
    buffer_load_dwordx4 v[116:119], v9, s[44:47], s62 offen offset:16 sc1
    s_waitcnt vmcnt(3)
    v_xor_b32 v96, s48, v80
    v_xor_b32 v97, s49, v81
    v_xor_b32 v98, s50, v82
    v_xor_b32 v99, s51, v83
    v_or_b32 v11, v96, v97
    v_or3_b32 v11, v11, v98, v99
    s_waitcnt vmcnt(2)
    v_xor_b32 v100, s48, v84
    v_xor_b32 v101, s49, v85
    v_xor_b32 v102, s50, v86
    v_xor_b32 v103, s51, v87
    v_or3_b32 v11, v11, v100, v101
    v_or3_b32 v11, v11, v102, v103
    v_cmp_ne_u32_sdwa vcc, v11, 0 src0_sel:BYTE_0 src1_sel:DWORD
    s_cbranch_vccz L_h_done
    s_sleep 1
    s_add_u32 s59, s59, 1
    s_cmp_lt_u32 s59, 64
    s_cbranch_scc1 L_h_poll
    v_xor_b32 v9, 524288, v9
    s_cmp_lt_u32 s59, 0x18000
    s_cbranch_scc1 L_h_poll
L_h_done:
    s_branch L_TAILM
L_TAILF:
    v_perm_b32 v16, v96, v96, v4
    v_perm_b32 v17, v96, v96, v5
    v_perm_b32 v18, v97, v97, v4
    v_perm_b32 v19, v97, v97, v5
    v_perm_b32 v20, v98, v98, v4
    v_perm_b32 v21, v98, v98, v5
    v_perm_b32 v22, v99, v99, v4
    v_perm_b32 v23, v99, v99, v5
    v_perm_b32 v24, v100, v100, v4
    v_perm_b32 v25, v100, v100, v5
    v_perm_b32 v26, v101, v101, v4
    v_perm_b32 v27, v101, v101, v5
    v_perm_b32 v28, v102, v102, v4
    v_perm_b32 v29, v102, v102, v5
    v_perm_b32 v30, v103, v103, v4
    v_perm_b32 v31, v103, v103, v5
    s_waitcnt vmcnt(7)
    v_swap_b32 v134, v136
    v_swap_b32 v135, v137
    s_nop 1
    v_mfma_f32_16x16x32_bf16 v[104:107], v[16:19], v[132:135], 0
    v_mfma_f32_16x16x32_bf16 v[108:111], v[16:19], v[136:139], 0
    s_waitcnt vmcnt(5)
    v_swap_b32 v142, v144
    v_swap_b32 v143, v145
    s_nop 1
    v_mfma_f32_16x16x32_bf16 v[104:107], v[20:23], v[140:143], v[104:107]
    v_mfma_f32_16x16x32_bf16 v[108:111], v[20:23], v[144:147], v[108:111]
    s_waitcnt vmcnt(3)
    v_swap_b32 v150, v152
    v_swap_b32 v151, v153
    s_nop 1
    v_mfma_f32_16x16x32_bf16 v[104:107], v[24:27], v[148:151], v[104:107]
    v_mfma_f32_16x16x32_bf16 v[108:111], v[24:27], v[152:155], v[108:111]
    s_waitcnt vmcnt(1)
    v_swap_b32 v158, v160
    v_swap_b32 v159, v161
    s_nop 1
    v_mfma_f32_16x16x32_bf16 v[104:107], v[28:31], v[156:159], v[104:107]
    v_mfma_f32_16x16x32_bf16 v[108:111], v[28:31], v[160:163], v[108:111]
    s_branch L_TAILE
L_W0F:
    v_lshlrev_b32 v13, 4, v0
    v_lshrrev_b32 v9, 1, v2
    v_lshlrev_b32 v9, 8, v9
    v_and_b32 v10, 7, v0
    v_lshl_add_u32 v9, v10, 5, v9
    v_and_b32 v10, 1, v2
    v_lshl_add_u32 v9, v10, 4, v9
    v_mov_b32 v14, 0xc0135761
    v_mov_b32 v15, 0
    s_mov_b32 s67, 0xbdd2d3e8
    s_mul_i32 s61, s4, 9
    s_add_u32 s61, s61, s5
    s_lshl_b32 s68, s61, 9
    s_add_u32 s68, s68, 339968
    v_mov_b32 v28, s49
    v_mov_b32 v29, s49
    v_mov_b32 v30, s49
    v_mov_b32 v31, s49
    s_add_u32 s69, s68, 524288
    s_mov_b32 exec_lo, 0x00ff00ff
    s_mov_b32 exec_hi, 0x00ff00ff
    buffer_store_dwordx4 v[28:31], v9, s[44:47], s69 offen
    s_mov_b64 exec, -1
    s_barrier
    s_barrier
    ds_read_b128 v[72:75], v13 offset:7168
    ds_read_b128 v[76:79], v13 offset:8192
    ds_read_b128 v[80:83], v13 offset:9216
    ds_read_b128 v[84:87], v13 offset:10240
    ds_read_b128 v[88:91], v13 offset:11264
    ds_read_b128 v[92:95], v13 offset:12288
    ds_read_b128 v[96:99], v13 offset:13312
    ds_read_b128 v[100:103], v13 offset:14336
    ds_read_b128 v[104:107], v13 offset:15360
    s_waitcnt lgkmcnt(7)
    v_pk_add_f32 v[72:73], v[72:73], v[76:77]
    v_pk_add_f32 v[74:75], v[74:75], v[78:79]
    s_waitcnt lgkmcnt(6)
    v_pk_add_f32 v[72:73], v[72:73], v[80:81]
    v_pk_add_f32 v[74:75], v[74:75], v[82:83]
    s_waitcnt lgkmcnt(5)
    v_pk_add_f32 v[72:73], v[72:73], v[84:85]
    v_pk_add_f32 v[74:75], v[74:75], v[86:87]
    s_waitcnt lgkmcnt(4)
    v_pk_add_f32 v[72:73], v[72:73], v[88:89]
    v_pk_add_f32 v[74:75], v[74:75], v[90:91]
    s_waitcnt lgkmcnt(3)
    v_pk_add_f32 v[72:73], v[72:73], v[92:93]
    v_pk_add_f32 v[74:75], v[74:75], v[94:95]
    s_waitcnt lgkmcnt(2)
    v_pk_add_f32 v[72:73], v[72:73], v[96:97]
    v_pk_add_f32 v[74:75], v[74:75], v[98:99]
    s_waitcnt lgkmcnt(1)
    v_pk_add_f32 v[72:73], v[72:73], v[100:101]
    v_pk_add_f32 v[74:75], v[74:75], v[102:103]
    s_waitcnt lgkmcnt(0)
    v_pk_add_f32 v[72:73], v[72:73], v[104:105]
    v_pk_add_f32 v[74:75], v[74:75], v[106:107]
    v_cvt_pk_bf16_f32 v16, v72, v73
    v_cvt_pk_bf16_f32 v17, v74, v75
    v_lshlrev_b32 v20, 16, v16
    v_and_b32 v21, s60, v16
    v_lshlrev_b32 v22, 16, v17
    v_and_b32 v23, s60, v17
    v_mul_f32 v24, v20, v20
    v_mul_f32 v25, v21, v21
    v_mul_f32 v26, v22, v22
    v_mul_f32 v27, v23, v23
    v_fma_f32 v24, v24, s67, v14
    v_fma_f32 v25, v25, s67, v14
    v_fma_f32 v26, v26, s67, v14
    v_fma_f32 v27, v27, s67, v14
    v_mul_f32 v24, v24, v20
    v_mul_f32 v25, v25, v21
    v_mul_f32 v26, v26, v22
    v_mul_f32 v27, v27, v23
    v_exp_f32 v24, v24
    v_exp_f32 v25, v25
    v_exp_f32 v26, v26
    v_exp_f32 v27, v27
    v_add_f32 v24, 1.0, v24
    v_add_f32 v25, 1.0, v25
    v_add_f32 v26, 1.0, v26
    v_add_f32 v27, 1.0, v27
    v_rcp_f32 v24, v24
    v_rcp_f32 v25, v25
    v_rcp_f32 v26, v26
    v_rcp_f32 v27, v27
    v_mul_f32 v24, v24, v20
    v_mul_f32 v25, v25, v21
    v_mul_f32 v26, v26, v22
    v_mul_f32 v27, v27, v23
    v_cvt_pk_bf16_f32 v16, v24, v25
    v_cvt_pk_bf16_f32 v17, v26, v27
    v_lshlrev_b32 v24, 16, v16
    v_and_b32 v25, s60, v16
    v_lshlrev_b32 v26, 16, v17
    v_and_b32 v27, s60, v17
    v_mul_f32 v24, v20, v24 row_ror:8 row_mask:0xf bank_mask:0xf
    v_mul_f32 v25, v21, v25 row_ror:8 row_mask:0xf bank_mask:0xf
    v_mul_f32 v26, v22, v26 row_ror:8 row_mask:0xf bank_mask:0xf
    v_mul_f32 v27, v23, v27 row_ror:8 row_mask:0xf bank_mask:0xf
    v_cvt_pk_bf16_f32 v24, v24, v24
    v_cvt_pk_bf16_f32 v25, v25, v25
    v_cvt_pk_bf16_f32 v26, v26, v26
    v_cvt_pk_bf16_f32 v27, v27, v27
    s_mov_b32 exec_lo, 0x00ff00ff
    s_mov_b32 exec_hi, 0x00ff00ff
    ds_write_b128 v9, v[24:27] offset:6144
    ds_write_b32 v15, v3 offset:5632
    v_bfi_b32 v28, v3, s48, v24
    v_bfi_b32 v29, v3, s49, v25
    v_bfi_b32 v30, v3, s50, v26
    v_bfi_b32 v31, v3, s51, v27
    s_add_u32 s69, s68, 524288
    buffer_store_dwordx4 v[28:31], v9, s[44:47], s69 offen
    buffer_store_dwordx4 v[28:31], v9, s[44:47], s68 offen sc1
    s_mov_b64 exec, -1
    s_barrier
    s_endpgm
L_CONS:
    s_mov_b32 s59, 0
    buffer_load_dwordx4 v[32:35], v64, s[44:47], 0 offen offset:0 sc1
    s_mov_b32 exec_hi, s20
    buffer_load_dwordx4 v[36:39], v64, s[44:47], 0 offen offset:2048 sc1
    s_mov_b64 exec, -1
    s_sleep 3
    buffer_load_dwordx4 v[40:43], v64, s[44:47], 0 offen offset:0 sc1
    s_mov_b32 exec_hi, s20
    buffer_load_dwordx4 v[44:47], v64, s[44:47], 0 offen offset:2048 sc1
    s_mov_b64 exec, -1
    s_sleep 3
L_f_poll:
    buffer_load_dwordx4 v[48:51], v64, s[44:47], 0 offen offset:0 sc1
    s_mov_b32 exec_hi, s20
    buffer_load_dwordx4 v[52:55], v64, s[44:47], 0 offen offset:2048 sc1
    s_mov_b64 exec, -1
    s_waitcnt vmcnt(5)
    v_xor_b32 v72, s48, v32
    v_xor_b32 v73, s49, v33
    v_xor_b32 v74, s50, v34
    v_xor_b32 v75, s51, v35
    v_or_b32 v11, v72, v73
    v_or3_b32 v11, v11, v74, v75
    s_waitcnt vmcnt(4)
    s_mov_b32 exec_hi, s20
    v_xor_b32 v76, s48, v36
    v_xor_b32 v77, s49, v37
    v_xor_b32 v78, s50, v38
    v_xor_b32 v79, s51, v39
    v_or3_b32 v11, v11, v76, v77
    v_or3_b32 v11, v11, v78, v79
    s_mov_b64 exec, -1
    v_cmp_ne_u32_sdwa vcc, v11, 0 src0_sel:BYTE_0 src1_sel:DWORD
    s_cbranch_vccz L_f_done
    buffer_load_dwordx4 v[32:35], v64, s[44:47], 0 offen offset:0 sc1
    s_mov_b32 exec_hi, s20
    buffer_load_dwordx4 v[36:39], v64, s[44:47], 0 offen offset:2048 sc1
    s_mov_b64 exec, -1
    s_waitcnt vmcnt(5)
    v_xor_b32 v72, s48, v40
    v_xor_b32 v73, s49, v41
    v_xor_b32 v74, s50, v42
    v_xor_b32 v75, s51, v43
    v_or_b32 v11, v72, v73
    v_or3_b32 v11, v11, v74, v75
    s_waitcnt vmcnt(4)
    s_mov_b32 exec_hi, s20
    v_xor_b32 v76, s48, v44
    v_xor_b32 v77, s49, v45
    v_xor_b32 v78, s50, v46
    v_xor_b32 v79, s51, v47
    v_or3_b32 v11, v11, v76, v77
    v_or3_b32 v11, v11, v78, v79
    s_mov_b64 exec, -1
    v_cmp_ne_u32_sdwa vcc, v11, 0 src0_sel:BYTE_0 src1_sel:DWORD
    s_cbranch_vccz L_f_done
    buffer_load_dwordx4 v[40:43], v64, s[44:47], 0 offen offset:0 sc1
    s_mov_b32 exec_hi, s20
    buffer_load_dwordx4 v[44:47], v64, s[44:47], 0 offen offset:2048 sc1
    s_mov_b64 exec, -1
    s_waitcnt vmcnt(5)
    v_xor_b32 v72, s48, v48
    v_xor_b32 v73, s49, v49
    v_xor_b32 v74, s50, v50
    v_xor_b32 v75, s51, v51
    v_or_b32 v11, v72, v73
    v_or3_b32 v11, v11, v74, v75
    s_waitcnt vmcnt(4)
    s_mov_b32 exec_hi, s20
    v_xor_b32 v76, s48, v52
    v_xor_b32 v77, s49, v53
    v_xor_b32 v78, s50, v54
    v_xor_b32 v79, s51, v55
    v_or3_b32 v11, v11, v76, v77
    v_or3_b32 v11, v11, v78, v79
    s_mov_b64 exec, -1
    v_cmp_ne_u32_sdwa vcc, v11, 0 src0_sel:BYTE_0 src1_sel:DWORD
    s_cbranch_vccz L_f_done
    s_add_u32 s59, s59, 1
    s_cmp_lt_u32 s59, 0x18000
    s_cbranch_scc1 L_f_poll
L_f_done:
    v_pk_add_f32 v[72:73], v[72:73], v[76:77]
    v_pk_add_f32 v[74:75], v[74:75], v[78:79]
    ds_write_b128 v68, v[72:75] offset:7168
    s_waitcnt lgkmcnt(0)
    s_barrier
    s_cmp_lg_u32 s57, 0
    s_cbranch_scc1 L_W0FE
    ds_read_b128 v[76:79], v67 offset:8192
    ds_read_b128 v[80:83], v67 offset:9216
    ds_read_b128 v[84:87], v67 offset:10240
    ds_read_b128 v[88:91], v67 offset:11264
    v_lshlrev_b32 v66, 16, v66
    s_waitcnt lgkmcnt(3)
    v_pk_add_f32 v[72:73], v[72:73], v[76:77]
    v_pk_add_f32 v[74:75], v[74:75], v[78:79]
    s_waitcnt lgkmcnt(1)
    v_pk_add_f32 v[80:81], v[80:81], v[84:85]
    v_pk_add_f32 v[82:83], v[82:83], v[86:87]
    s_waitcnt lgkmcnt(0)
    v_pk_add_f32 v[76:77], v[80:81], v[88:89]
    v_pk_add_f32 v[78:79], v[82:83], v[90:91]
    s_nop 0
    v_permlane32_swap_b32 v72, v76
    v_permlane32_swap_b32 v73, v77
    v_permlane32_swap_b32 v74, v78
    v_permlane32_swap_b32 v75, v79
    v_pk_add_f32 v[72:73], v[72:73], v[76:77]
    v_pk_add_f32 v[74:75], v[74:75], v[78:79]
    s_nop 0
    v_permlane16_swap_b32 v72, v73
    v_permlane16_swap_b32 v74, v75
    v_add_f32 v72, v72, v73
    v_add_f32 v74, v74, v75
    s_nop 0
    v_add_f32 v72, v72, v72 row_ror:4 row_mask:0xf bank_mask:0xf
    v_add_f32 v74, v74, v74 row_ror:4 row_mask:0xf bank_mask:0xf
    s_nop 0
    v_add_f32 v72, v72, v72 row_ror:8 row_mask:0xf bank_mask:0xf
    v_add_f32 v74, v74, v74 row_ror:8 row_mask:0xf bank_mask:0xf
    s_nop 1
    v_permlane32_swap_b32 v72, v74
    v_cvt_pk_bf16_f32 v72, v72, v74
    v_lshlrev_b32 v73, 16, v72
    v_and_b32 v74, s60, v72
    v_add_f32 v66, v66, v73
    v_cvt_pk_bf16_f32 v66, v66, v66
    v_and_b32 v66, s60, v66
    v_add_f32 v66, v66, v74
    v_cvt_pk_bf16_f32 v66, v66, v66
    s_mov_b32 exec_lo, 0x000f000f
    s_mov_b32 exec_hi, 0x000f000f
    buffer_store_short v66, v65, s[36:39], 0 offen
    s_mov_b64 exec, -1
    s_cmp_lg_u32 s56, 64
    s_cbranch_scc1 L_W0FE
    s_add_u32 s52, s52, 1
    v_mov_b32 v9, s52
    v_mov_b32 v10, 0
    s_mov_b64 exec, 1
    buffer_store_dword v9, v10, s[44:47], 0 offen sc1
    s_mov_b64 exec, -1
L_W0FE:
    s_endpgm
L_EXIT:
    s_endpgm
.section .rodata,"a"
.p2align 6
.amdhsa_kernel parallel_sum__sliding_block_cached__geglu_ffn__decode_kernel
  .amdhsa_next_free_vgpr 168
  .amdhsa_next_free_sgpr 102
  .amdhsa_accum_offset 168
  .amdhsa_group_segment_fixed_size 0
  .amdhsa_kernarg_size 96
  .amdhsa_user_sgpr_count 2
  .amdhsa_user_sgpr_kernarg_segment_ptr 1
  .amdhsa_system_sgpr_workgroup_id_x 1
  .amdhsa_float_denorm_mode_32 3
.end_amdhsa_kernel
```
